```python
import torch

def _softmax(x, axis=-1):
    return torch.softmax(x, dim=axis)
def _gelu(x):
    return torch.nn.functional.gelu(x, approximate="tanh")
def _silu(x):
    return torch.nn.functional.silu(x)
def _sigmoid(x):
    return torch.sigmoid(x)
def _layernorm(x, axis=-1, eps=1e-5):
    m = x.mean(dim=axis, keepdim=True)
    v = x.var(dim=axis, keepdim=True, unbiased=False)
    return (x - m) / torch.sqrt(v + eps)
def _scatter_add(tgt, idx, src, axis=0):
    return tgt.clone().index_add_(axis, idx, src)
def _segment_sum(src, seg, n):
    out = torch.zeros((n,) + src.shape[1:], dtype=src.dtype)
    return out.index_add_(0, seg, src)
def _pad(x, pw):
    flat = tuple(v for pair in reversed(pw) for v in pair)
    return torch.nn.functional.pad(x, flat)

kernel_name = 'concat_heads__linear_kernel_hedgehog__linear_attn_block__prompt'

def setup_inputs():

    _w = (lambda a: (lambda t: t.to(torch.bfloat16) if t.is_floating_point() else t)(torch.as_tensor(a)))
    def _A_setup():
        B, S, D, H = 1, 2048, 512, 32
        Dh = D // H
        return {
            "x": _w((lambda *s: torch.randn(*s, dtype=torch.bfloat16) * 0.4)(B, S, D)),
            "wqkv": _w((lambda *s: torch.randn(*s, dtype=torch.bfloat16) * 0.4)(D, 3 * D)),
            "w_phi": _w((lambda *s: torch.randn(*s, dtype=torch.bfloat16) * 0.4)(H, Dh, Dh) * (Dh ** -0.5)),
            "wo": _w((lambda *s: torch.randn(*s, dtype=torch.bfloat16) * 0.05)(D, D)),
        }
    _A_in = _A_setup()

    def _B_setup():
        B, S, D = 1, 2048, 512
        return {
            "x": _w((lambda *s: torch.randn(*s, dtype=torch.bfloat16) * 0.05)(B, S, D)),
            "wqkv": _w((lambda *s: torch.randn(*s, dtype=torch.bfloat16) * 0.8)(D, 3 * D)),
            "wo": _w((lambda *s: torch.randn(*s, dtype=torch.bfloat16) * 0.4)(D, D)),
        }
    _B_in = _B_setup()

    return {
        "A_x": _A_in["x"],
        "A_wqkv": _A_in["wqkv"],
        "A_w_phi": _A_in["w_phi"],
        "A_wo": _A_in["wo"],
        "B_x": _B_in["x"],
        "B_wqkv": _B_in["wqkv"],
        "B_wo": _B_in["wo"],
    }

def reference(A_x, A_wqkv, A_w_phi, A_wo, B_x, B_wqkv, B_wo):
    def _A_ref(x, wqkv, w_phi, wo):
        B, S, D = x.shape
        H = 32; Dh = D // H
        qkv = (lambda x, *d: x.permute(*d))((x @ wqkv).reshape(B, S, 3, H, Dh), 2, 0, 3, 1, 4)
        q, k, v = qkv[0], qkv[1], qkv[2]
        pq = torch.einsum("bhsd,hdf->bhsf", q, w_phi)
        pk = torch.einsum("bhsd,hdf->bhsf", k, w_phi)
        phi_q = torch.concatenate([_softmax(pq, axis=-1), _softmax(-pq, axis=-1)], axis=-1)
        phi_k = torch.concatenate([_softmax(pk, axis=-1), _softmax(-pk, axis=-1)], axis=-1)
        kv = torch.einsum("bhsf,bhsd->bhfd", phi_k, v)
        z  = torch.einsum("bhsf->bhf", phi_k)
        num = torch.einsum("bhqf,bhfd->bhqd", phi_q, kv)
        den = torch.einsum("bhqf,bhf->bhq", phi_q, z)[..., None] + 1e-6
        o = num / den
        return (lambda x, *d: x.permute(*d))(o, 0, 2, 1, 3).reshape(B, S, D) @ wo

    def _B_ref(x, wqkv, wo):
        B, S, D = x.shape
        H = 32; Dh = D // H
        qkv = (lambda x, *d: x.permute(*d))((x @ wqkv).reshape(B, S, 3, H, Dh), 2, 0, 3, 1, 4)
        q, k, v = qkv[0], qkv[1], qkv[2]
        phi = lambda t: torch.where(t > 0, t + 1, torch.exp(t)) + 1e-6
        pq, pk = phi(q), phi(k)
        kv = torch.einsum("bhsd,bhse->bhde", pk, v)
        z = torch.einsum("bhsd->bhd", pk)
        num = torch.einsum("bhqd,bhde->bhqe", pq, kv)
        den = torch.einsum("bhqd,bhd->bhq", pq, z)[..., None] + 1e-6
        o = num / den
        return (lambda x, *d: x.permute(*d))(o, 0, 2, 1, 3).reshape(B, S, D) @ wo

    a = _A_ref(A_x, A_wqkv, A_w_phi, A_wo)
    b = _B_ref(B_x, B_wqkv, B_wo)
    return torch.concatenate([a, b], axis=-1)
```

```asm
; @launch grid=(256,1,1) block=(512,1,1) lds=163840
.amdgcn_target "amdgcn-amd-amdhsa--gfx950"
.text
.globl concat_heads__linear_kernel_hedgehog__linear_attn_block__prompt_kernel
.p2align 8
.type concat_heads__linear_kernel_hedgehog__linear_attn_block__prompt_kernel,@function
concat_heads__linear_kernel_hedgehog__linear_attn_block__prompt_kernel:
  s_cmp_ge_u32 s2, 256
  s_cbranch_scc1 L_exit
  s_bitcmp1_b32 s2, 2
  s_cbranch_scc1 L_progB
  s_load_dwordx4 s[44:47], s[0:1], 0
  s_load_dwordx4 s[52:55], s[0:1], 16
  s_load_dwordx2 s[56:57], s[0:1], 56
  s_load_dwordx2 s[62:63], s[0:1], 72
  v_and_b32 v1, 63, v0
  v_lshrrev_b32 v14, 6, v0
  s_nop 0
  v_readfirstlane_b32 s34, v14
  s_lshr_b32 s40, s2, 3
  s_and_b32 s32, s2, 1
  s_lshl_b32 s32, s32, 3
  s_and_b32 s41, s40, 7
  s_add_u32 s32, s32, s41
  s_bfe_u32 s33, s2, 0x10001
  s_lshl_b32 s33, s33, 2
  s_lshr_b32 s41, s40, 3
  s_add_u32 s33, s33, s41
  s_and_b32 s35, s34, 3
  s_lshr_b32 s36, s34, 2
  s_and_b32 s40, s34, 1
  s_lshl_b32 s40, s40, 2
  v_lshrrev_b32 v14, 4, v1
  v_add_u32 v14, s40, v14
  v_and_b32 v15, 7, v1
  v_xor_b32 v14, v14, v15
  v_lshlrev_b32 v14, 4, v14
  v_lshrrev_b32 v15, 3, v1
  v_lshl_add_u32 v2, v15, 10, v14
  v_bfe_u32 v14, v1, 4, 1
  v_lshlrev_b32 v14, 2, v14
  v_and_b32 v3, 7, v1
  v_xor_b32 v14, v14, v3
  v_lshlrev_b32 v14, 4, v14
  v_mul_u32_u24 v3, 3072, v15
  v_add_u32 v3, v3, v14
  s_lshl_b32 s37, s32, 17
  s_lshl_b32 s40, s34, 13
  s_add_u32 s37, s37, s40
  s_mul_i32 s38, s34, 24576
  s_lshl_b32 s40, s33, 7
  s_add_u32 s38, s38, s40
  v_lshlrev_b32 v13, 4, v1
  s_waitcnt lgkmcnt(0)
  s_add_u32 s62, s62, 0xf000000
  s_addc_u32 s63, s63, 0
  s_mov_b32 s4, s44
  s_mov_b32 s5, s45
  s_mov_b32 s6, 0x200000
  s_mov_b32 s7, 0x20000
  s_mov_b32 s8, s46
  s_mov_b32 s9, s47
  s_mov_b32 s10, 0x180000
  s_mov_b32 s11, 0x20000
  s_mov_b32 s16, s62
  s_mov_b32 s17, s63
  s_mov_b32 s18, 0x1000000
  s_mov_b32 s19, 0x20000
  s_mov_b32 s28, s52
  s_mov_b32 s29, s53
  s_mov_b32 s30, 0x4000
  s_mov_b32 s31, 0x20000
  s_mov_b32 s12, s54
  s_mov_b32 s13, s55
  s_mov_b32 s14, 0x80000
  s_mov_b32 s15, 0x20000
  s_mov_b32 s20, s56
  s_mov_b32 s21, s57
  s_mov_b32 s22, 0x400000
  s_mov_b32 s23, 0x20000
  s_lshl_b32 s55, s34, 10
  s_and_b32 s100, s33, 3
  s_lshl_b32 s100, s100, 1
  s_add_u32 s100, s100, s32
  s_and_b32 s100, s100, 7
  s_cmp_ge_u32 s34, 2
  s_cbranch_scc1 P0_nn1
  v_mov_b32 v14, 0
  buffer_load_dword v16, v14, s[16:19], 0 offen offset:0 sc1
  s_lshl_b32 s40, s33, 11
  s_add_u32 s40, s40, s55
  s_add_u32 m0, s55, 131072
  s_nop 0
  buffer_load_dwordx4 v13, s[28:31], s40 offen lds
P0_nn1:
  s_add_u32 s101, s100, 0
  s_and_b32 s101, s101, 7
  s_mul_i32 s101, s101, 128
  s_add_u32 s40, s37, s101
  s_add_u32 m0, s55, 0
  s_nop 0
  buffer_load_dwordx4 v2, s[4:7], s40 offen lds
  s_add_u32 s40, s40, 65536
  s_add_u32 m0, s55, 8192
  s_nop 0
  buffer_load_dwordx4 v2, s[4:7], s40 offen lds
  s_add_u32 s101, s100, 0
  s_and_b32 s101, s101, 7
  s_mul_i32 s101, s101, 196608
  s_add_u32 s40, s38, s101
  s_add_u32 s40, s40, 1024
  s_add_u32 m0, s55, 16384
  s_nop 0
  buffer_load_dwordx4 v3, s[8:11], s40 offen lds
  s_add_u32 s40, s40, 1024
  s_add_u32 m0, s55, 24576
  s_nop 0
  buffer_load_dwordx4 v3, s[8:11], s40 offen lds
  s_barrier
  s_lshl_b32 s40, s33, 4
  s_add_u32 s40, s40, 0
  s_mul_i32 s51, s40, 9216
  s_add_u32 s51, s51, 1048576
  s_mul_i32 s57, s32, 9216
  s_add_u32 s57, s57, s51
  s_lshl_b32 s52, s32, 17
  s_add_u32 s52, s52, 8388608
  s_lshl_b32 s53, s33, 13
  s_add_u32 s53, s53, 4194304
  s_mov_b32 s46, 0x0000ffff
  s_mov_b32 s47, 0x0000ffff
  s_mov_b32 s48, 0xffff0000
  s_mov_b32 s49, 0xffff0000
  s_mov_b32 s60, 0x00110000
  s_mov_b32 s61, 0x00110000
  s_mov_b32 s62, 0x00000011
  s_mov_b32 s63, 0x00000011
  v_lshrrev_b32 v15, 4, v1
  v_lshlrev_b32 v14, 2, v15
  v_and_b32 v4, 15, v1
  v_xor_b32 v14, v14, v4
  v_lshlrev_b32 v14, 4, v14
  v_lshl_add_u32 v4, v15, 10, v14
  s_and_b32 s40, s33, 3
  s_lshl_b32 s40, s40, 8
  s_lshl_b32 s56, s34, 12
  s_add_u32 s56, s56, s40
  v_and_b32 v14, 31, v1
  s_lshl_b32 s40, s35, 5
  v_add_u32 v15, s40, v14
  v_lshlrev_b32 v10, 6, v15
  v_lshlrev_b32 v15, 7, v15
  v_bfe_u32 v14, v1, 1, 3
  v_lshrrev_b32 v5, 5, v1
  v_xor_b32 v5, v5, v14
  v_lshl_add_u32 v10, v5, 3, v10
  v_lshl_add_u32 v5, v5, 4, v15
  v_xor_b32 v6, 32, v5
  v_xor_b32 v7, 64, v5
  v_xor_b32 v8, 96, v5
  v_lshrrev_b32 v14, 5, v1
  v_lshlrev_b32 v14, 3, v14
  v_bfe_u32 v15, v1, 2, 2
  v_add_u32 v14, v14, v15
  v_lshlrev_b32 v9, 7, v14
  v_bfe_u32 v14, v1, 4, 1
  v_lshlrev_b32 v14, 1, v14
  v_bfe_u32 v15, v1, 1, 1
  v_add_u32 v14, v14, v15
  s_lshl_b32 s40, s36, 2
  v_add_u32 v14, s40, v14
  v_bfe_u32 v15, v1, 3, 1
  v_lshlrev_b32 v15, 2, v15
  v_xor_b32 v14, v14, v15
  v_lshl_add_u32 v9, v14, 4, v9
  v_and_b32 v15, 1, v1
  v_lshl_add_u32 v9, v15, 3, v9
  v_lshrrev_b32 v14, 5, v1
  v_bfe_u32 v15, v1, 2, 2
  v_lshl_add_u32 v15, v14, 2, v15
  v_lshlrev_b32 v11, 6, v15
  v_lshlrev_b32 v14, 1, v14
  v_bfe_u32 v15, v1, 3, 1
  v_add_u32 v14, v14, v15
  v_bfe_u32 v15, v1, 4, 1
  v_lshlrev_b32 v15, 2, v15
  v_xor_b32 v14, v14, v15
  v_and_b32 v15, 3, v1
  v_xor_b32 v14, v14, v15
  v_lshl_add_u32 v11, v14, 3, v11
  v_xor_b32 v12, 32, v11
  v_add_u32 v12, 512, v12
  v_mov_b32 v126, 0x3fb8aa3b
  v_mov_b32 v127, 0x358637bd
  s_lshl_b32 s64, s35, 15
  s_lshl_b32 s42, s33, 12
  s_add_u32 s64, s64, s42
  s_lshl_b32 s42, s36, 11
  s_add_u32 s64, s64, s42
  s_add_u32 s64, s64, s52
  s_lshl_b32 s65, s36, 11
  s_add_u32 s65, s65, s53
  s_lshl_b32 s66, s36, 7
  s_add_u32 s66, s66, s53
  s_add_u32 s66, s66, 4096
  s_lshr_b32 s58, s32, 3
  s_lshl_b32 s58, s58, 1
  s_and_b32 s42, s32, 1
  s_add_u32 s58, s58, s42
  s_lshl_b32 s58, s58, 11
  s_and_b32 s42, s32, 2
  s_lshl_b32 s42, s42, 8
  s_add_u32 s58, s58, s42
  s_and_b32 s42, s32, 4
  s_lshl_b32 s42, s42, 6
  s_add_u32 s58, s58, s42
  s_lshl_b32 s42, s34, 5
  s_add_u32 s58, s58, s42
  s_lshl_b32 s59, s32, 5
  s_lshr_b32 s67, s32, 2
  s_lshl_b32 s67, s67, 10
  s_and_b32 s42, s32, 3
  s_lshl_b32 s42, s42, 3
  s_add_u32 s42, s42, s34
  s_lshl_b32 s42, s42, 5
  s_add_u32 s67, s67, s42
  s_lshr_b32 s68, s32, 2
  s_lshl_b32 s68, s68, 6
  s_and_b32 s42, s32, 3
  s_lshl_b32 s42, s42, 3
  s_add_u32 s68, s68, s42
  s_add_u32 s58, s58, s51
  s_add_u32 s59, s59, s51
  s_add_u32 s59, s59, 8192
  s_add_u32 s67, s67, s53
  s_add_u32 s68, s68, s53
  s_add_u32 s68, s68, 4096
  s_and_b32 s42, s34, 1
  s_lshl_b32 s71, s42, 13
  s_add_u32 s71, s71, 32768
  s_lshl_b32 s42, s42, 1
  s_bfe_u32 s43, s34, 0x10001
  s_add_u32 s42, s42, s43
  s_lshl_b32 s70, s42, 13
  s_lshl_b32 s43, s42, 11
  s_lshl_b32 s42, s42, 7
  s_add_u32 s42, s42, 8192
  s_bitcmp1_b32 s34, 2
  s_cselect_b32 s69, s42, s43
  s_add_u32 s69, s69, s57
  s_lshr_b32 s42, s33, 2
  s_lshl_b32 s42, s42, 16
  s_add_u32 s42, s42, s52
  s_lshl_b32 s43, s35, 10
  s_add_u32 s42, s42, s43
  s_add_u32 s43, s36, s32
  s_add_u32 s73, s43, 0
  s_and_b32 s73, s73, 7
  s_lshl_b32 s73, s73, 12
  s_add_u32 s73, s73, s42
  s_add_u32 s74, s43, 2
  s_and_b32 s74, s74, 7
  s_lshl_b32 s74, s74, 12
  s_add_u32 s74, s74, s42
  s_add_u32 s75, s43, 4
  s_and_b32 s75, s75, 7
  s_lshl_b32 s75, s75, 12
  s_add_u32 s75, s75, s42
  s_add_u32 s76, s43, 6
  s_and_b32 s76, s76, 7
  s_lshl_b32 s76, s76, 12
  s_add_u32 s76, s76, s42
  s_add_u32 s77, s43, 0
  s_and_b32 s77, s77, 7
  s_lshl_b32 s77, s77, 12
  s_add_u32 s77, s77, s42
  s_add_u32 s77, s77, 32768
  s_add_u32 s78, s43, 2
  s_and_b32 s78, s78, 7
  s_lshl_b32 s78, s78, 12
  s_add_u32 s78, s78, s42
  s_add_u32 s78, s78, 32768
  s_add_u32 s79, s43, 4
  s_and_b32 s79, s79, 7
  s_lshl_b32 s79, s79, 12
  s_add_u32 s79, s79, s42
  s_add_u32 s79, s79, 32768
  s_add_u32 s80, s43, 6
  s_and_b32 s80, s80, 7
  s_lshl_b32 s80, s80, 12
  s_add_u32 s80, s80, s42
  s_add_u32 s80, s80, 32768
  s_add_u32 s81, s32, 0
  s_and_b32 s81, s81, 7
  s_lshl_b32 s81, s81, 16
  s_add_u32 s81, s81, s56
  s_add_u32 s82, s32, 1
  s_and_b32 s82, s82, 7
  s_lshl_b32 s82, s82, 16
  s_add_u32 s82, s82, s56
  s_add_u32 s83, s32, 2
  s_and_b32 s83, s83, 7
  s_lshl_b32 s83, s83, 16
  s_add_u32 s83, s83, s56
  s_add_u32 s84, s32, 3
  s_and_b32 s84, s84, 7
  s_lshl_b32 s84, s84, 16
  s_add_u32 s84, s84, s56
  s_add_u32 s85, s32, 4
  s_and_b32 s85, s85, 7
  s_lshl_b32 s85, s85, 16
  s_add_u32 s85, s85, s56
  s_add_u32 s86, s32, 5
  s_and_b32 s86, s86, 7
  s_lshl_b32 s86, s86, 16
  s_add_u32 s86, s86, s56
  s_add_u32 s87, s32, 6
  s_and_b32 s87, s87, 7
  s_lshl_b32 s87, s87, 16
  s_add_u32 s87, s87, s56
  s_add_u32 s88, s32, 7
  s_and_b32 s88, s88, 7
  s_lshl_b32 s88, s88, 16
  s_add_u32 s88, s88, s56
  s_lshl_b32 s72, s32, 7
  s_lshr_b32 s42, s33, 2
  s_lshl_b32 s42, s42, 6
  s_add_u32 s72, s72, s42
  s_lshl_b32 s72, s72, 11
  s_and_b32 s42, s33, 3
  s_lshl_b32 s42, s42, 8
  s_add_u32 s72, s72, s42
  s_add_u32 s72, s72, 0
  s_add_u32 s101, s100, 1
  s_and_b32 s101, s101, 7
  s_mul_i32 s101, s101, 128
  s_add_u32 s40, s37, s101
  s_add_u32 m0, s55, 32768
  s_nop 0
  buffer_load_dwordx4 v2, s[4:7], s40 offen lds
  s_add_u32 s40, s40, 65536
  s_add_u32 m0, s55, 40960
  s_nop 0
  buffer_load_dwordx4 v2, s[4:7], s40 offen lds
  s_add_u32 s101, s100, 1
  s_and_b32 s101, s101, 7
  s_mul_i32 s101, s101, 196608
  s_add_u32 s40, s38, s101
  s_add_u32 s40, s40, 1024
  s_add_u32 m0, s55, 49152
  s_nop 0
  buffer_load_dwordx4 v3, s[8:11], s40 offen lds
  s_add_u32 s40, s40, 1024
  s_add_u32 m0, s55, 57344
  s_nop 0
  buffer_load_dwordx4 v3, s[8:11], s40 offen lds
  s_waitcnt vmcnt(4)
  s_cmp_eq_u32 s34, 0
  s_cbranch_scc0 P0_tg2
  v_mov_b32 v14, 133120
  ds_write_b32 v14, v16
  s_waitcnt lgkmcnt(0)
P0_tg2:
  v_add_u32 v112, 0, v5
  v_add_u32 v113, 0, v6
  v_add_u32 v114, 0, v7
  v_add_u32 v115, 0, v8
  v_add_u32 v116, 16384, v9
  s_barrier
  s_add_u32 s101, s100, 2
  s_and_b32 s101, s101, 7
  s_mul_i32 s101, s101, 128
  s_add_u32 s40, s37, s101
  s_add_u32 m0, s55, 65536
  s_nop 0
  buffer_load_dwordx4 v2, s[4:7], s40 offen lds
  v_mov_b32 v14, 133120
  ds_read_b32 v118, v14
  ds_read_b128 v[128:131], v112
  ds_read_b64_tr_b16 v[48:49], v116 offset:0
  ds_read_b64_tr_b16 v[50:51], v116 offset:512
  ds_read_b128 v[132:135], v113
  ds_read_b64_tr_b16 v[52:53], v116 offset:2048
  ds_read_b64_tr_b16 v[54:55], v116 offset:2560
  ds_read_b128 v[136:139], v114
  ds_read_b64_tr_b16 v[56:57], v116 offset:4096
  ds_read_b64_tr_b16 v[58:59], v116 offset:4608
  ds_read_b128 v[140:143], v115
  ds_read_b64_tr_b16 v[60:61], v116 offset:6144
  ds_read_b64_tr_b16 v[62:63], v116 offset:6656
  s_waitcnt lgkmcnt(12)
  v_readfirstlane_b32 s54, v118
  s_nop 3
  s_add_u32 s54, s54, 1
  s_and_b32 s96, s54, 1
  s_and_b32 s42, s54, 2
  s_lshl_b32 s42, s42, 15
  s_or_b32 s96, s96, s42
  s_and_b32 s25, s54, 0xff
  s_add_u32 s42, s54, 1
  s_and_b32 s42, s42, 0xff
  s_lshl_b32 s42, s42, 8
  s_or_b32 s25, s25, s42
  s_add_u32 s42, s54, 2
  s_and_b32 s42, s42, 0xff
  s_lshl_b32 s42, s42, 16
  s_or_b32 s25, s25, s42
  s_add_u32 s42, s54, 3
  s_and_b32 s42, s42, 0xff
  s_lshl_b32 s42, s42, 24
  s_or_b32 s25, s25, s42
  v_lshrrev_b32 v14, 5, v1
  v_bfe_u32 v15, v1, 2, 2
  v_lshl_add_u32 v14, v14, 2, v15
  v_lshlrev_b32 v14, 5, v14
  v_and_b32 v15, 3, v1
  v_lshl_add_u32 v14, v15, 3, v14
  s_lshl_b32 s41, s36, 10
  s_add_u32 s41, s41, 131072
  v_add_u32 v14, s41, v14
  ds_read_b64_tr_b16 v[104:105], v14 offset:0
  ds_read_b64_tr_b16 v[106:107], v14 offset:256
  ds_read_b64_tr_b16 v[108:109], v14 offset:512
  ds_read_b64_tr_b16 v[110:111], v14 offset:768
  s_waitcnt lgkmcnt(0)
  s_mov_b64 exec, s[48:49]
  v_mov_b32 v104, 0
  v_mov_b32 v105, 0
  v_mov_b32 v106, 0
  v_mov_b32 v107, 0
  s_mov_b64 exec, s[46:47]
  v_mov_b32 v108, 0
  v_mov_b32 v109, 0
  v_mov_b32 v110, 0
  v_mov_b32 v111, 0
  s_mov_b64 exec, -1
  ds_read_b64_tr_b16 v[72:73], v116 offset:8192
  ds_read_b64_tr_b16 v[74:75], v116 offset:8704
  ds_read_b64_tr_b16 v[76:77], v116 offset:10240
  ds_read_b64_tr_b16 v[78:79], v116 offset:10752
  ds_read_b64_tr_b16 v[80:81], v116 offset:12288
  ds_read_b64_tr_b16 v[82:83], v116 offset:12800
  ds_read_b64_tr_b16 v[84:85], v116 offset:14336
  ds_read_b64_tr_b16 v[86:87], v116 offset:14848
  v_mfma_f32_32x32x16_bf16 v[16:31], v[48:51], v[128:131], 0
  s_add_u32 s40, s40, 65536
  s_add_u32 m0, s55, 73728
  s_nop 0
  buffer_load_dwordx4 v2, s[4:7], s40 offen lds
  v_mfma_f32_32x32x16_bf16 v[16:31], v[52:55], v[132:135], v[16:31]
  s_add_u32 s101, s100, 2
  s_and_b32 s101, s101, 7
  s_mul_i32 s101, s101, 196608
  s_add_u32 s40, s38, s101
  s_add_u32 s40, s40, 1024
  s_add_u32 m0, s55, 81920
  s_nop 0
  buffer_load_dwordx4 v3, s[8:11], s40 offen lds
  v_mfma_f32_32x32x16_bf16 v[16:31], v[56:59], v[136:139], v[16:31]
  s_add_u32 s40, s40, 1024
  s_add_u32 m0, s55, 90112
  s_nop 0
  buffer_load_dwordx4 v3, s[8:11], s40 offen lds
  v_mfma_f32_32x32x16_bf16 v[16:31], v[60:63], v[140:143], v[16:31]
  s_waitcnt vmcnt(4)
  v_add_u32 v112, 32768, v5
  v_add_u32 v113, 32768, v6
  v_add_u32 v114, 32768, v7
  v_add_u32 v115, 32768, v8
  v_add_u32 v116, 49152, v9
  s_barrier
  s_waitcnt lgkmcnt(6)
  v_mfma_f32_32x32x16_bf16 v[32:47], v[128:131], v[72:75], 0
  ds_read_b128 v[144:147], v112
  ds_read_b64_tr_b16 v[48:49], v116 offset:0
  ds_read_b64_tr_b16 v[50:51], v116 offset:512
  s_add_u32 s101, s100, 3
  s_and_b32 s101, s101, 7
  s_mul_i32 s101, s101, 128
  s_add_u32 s40, s37, s101
  s_add_u32 m0, s55, 98304
  s_nop 0
  buffer_load_dwordx4 v2, s[4:7], s40 offen lds
  s_waitcnt lgkmcnt(7)
  v_mfma_f32_32x32x16_bf16 v[32:47], v[132:135], v[76:79], v[32:47]
  ds_read_b128 v[148:151], v113
  ds_read_b64_tr_b16 v[52:53], v116 offset:2048
  ds_read_b64_tr_b16 v[54:55], v116 offset:2560
  s_add_u32 s40, s40, 65536
  s_add_u32 m0, s55, 106496
  s_nop 0
  buffer_load_dwordx4 v2, s[4:7], s40 offen lds
  s_waitcnt lgkmcnt(8)
  v_mfma_f32_32x32x16_bf16 v[32:47], v[136:139], v[80:83], v[32:47]
  ds_read_b128 v[152:155], v114
  ds_read_b64_tr_b16 v[56:57], v116 offset:4096
  ds_read_b64_tr_b16 v[58:59], v116 offset:4608
  s_waitcnt lgkmcnt(9)
  v_mfma_f32_32x32x16_bf16 v[32:47], v[140:143], v[84:87], v[32:47]
  ds_read_b128 v[156:159], v115
  ds_read_b64_tr_b16 v[60:61], v116 offset:6144
  ds_read_b64_tr_b16 v[62:63], v116 offset:6656
  s_waitcnt lgkmcnt(9)
  v_mfma_f32_32x32x16_bf16 v[16:31], v[48:51], v[144:147], v[16:31]
  ds_read_b64_tr_b16 v[72:73], v116 offset:8192
  ds_read_b64_tr_b16 v[74:75], v116 offset:8704
  s_add_u32 s101, s100, 3
  s_and_b32 s101, s101, 7
  s_mul_i32 s101, s101, 196608
  s_add_u32 s40, s38, s101
  s_add_u32 s40, s40, 1024
  s_add_u32 m0, s55, 114688
  s_nop 0
  buffer_load_dwordx4 v3, s[8:11], s40 offen lds
  s_waitcnt lgkmcnt(8)
  v_mfma_f32_32x32x16_bf16 v[16:31], v[52:55], v[148:151], v[16:31]
  ds_read_b64_tr_b16 v[76:77], v116 offset:10240
  ds_read_b64_tr_b16 v[78:79], v116 offset:10752
  s_add_u32 s40, s40, 1024
  s_add_u32 m0, s55, 122880
  s_nop 0
  buffer_load_dwordx4 v3, s[8:11], s40 offen lds
  s_waitcnt lgkmcnt(7)
  v_mfma_f32_32x32x16_bf16 v[16:31], v[56:59], v[152:155], v[16:31]
  ds_read_b64_tr_b16 v[80:81], v116 offset:12288
  ds_read_b64_tr_b16 v[82:83], v116 offset:12800
  s_waitcnt lgkmcnt(6)
  v_mfma_f32_32x32x16_bf16 v[16:31], v[60:63], v[156:159], v[16:31]
  ds_read_b64_tr_b16 v[84:85], v116 offset:14336
  ds_read_b64_tr_b16 v[86:87], v116 offset:14848
  s_waitcnt vmcnt(4)
  v_add_u32 v112, 65536, v5
  v_add_u32 v113, 65536, v6
  v_add_u32 v114, 65536, v7
  v_add_u32 v115, 65536, v8
  v_add_u32 v116, 81920, v9
  s_barrier
  s_waitcnt lgkmcnt(6)
  v_mfma_f32_32x32x16_bf16 v[32:47], v[144:147], v[72:75], v[32:47]
  ds_read_b128 v[160:163], v112
  ds_read_b64_tr_b16 v[48:49], v116 offset:0
  ds_read_b64_tr_b16 v[50:51], v116 offset:512
  s_add_u32 s101, s100, 4
  s_and_b32 s101, s101, 7
  s_mul_i32 s101, s101, 128
  s_add_u32 s40, s37, s101
  s_add_u32 m0, s55, 131072
  s_nop 0
  buffer_load_dwordx4 v2, s[4:7], s40 offen lds
  s_waitcnt lgkmcnt(7)
  v_mfma_f32_32x32x16_bf16 v[32:47], v[148:151], v[76:79], v[32:47]
  ds_read_b128 v[164:167], v113
  ds_read_b64_tr_b16 v[52:53], v116 offset:2048
  ds_read_b64_tr_b16 v[54:55], v116 offset:2560
  s_add_u32 s40, s40, 65536
  s_add_u32 m0, s55, 139264
  s_nop 0
  buffer_load_dwordx4 v2, s[4:7], s40 offen lds
  s_waitcnt lgkmcnt(8)
  v_mfma_f32_32x32x16_bf16 v[32:47], v[152:155], v[80:83], v[32:47]
  ds_read_b128 v[168:171], v114
  ds_read_b64_tr_b16 v[56:57], v116 offset:4096
  ds_read_b64_tr_b16 v[58:59], v116 offset:4608
  s_waitcnt lgkmcnt(9)
  v_mfma_f32_32x32x16_bf16 v[32:47], v[156:159], v[84:87], v[32:47]
  ds_read_b128 v[172:175], v115
  ds_read_b64_tr_b16 v[60:61], v116 offset:6144
  ds_read_b64_tr_b16 v[62:63], v116 offset:6656
  s_waitcnt lgkmcnt(9)
  v_mfma_f32_32x32x16_bf16 v[16:31], v[48:51], v[160:163], v[16:31]
  ds_read_b64_tr_b16 v[72:73], v116 offset:8192
  ds_read_b64_tr_b16 v[74:75], v116 offset:8704
  s_add_u32 s101, s100, 4
  s_and_b32 s101, s101, 7
  s_mul_i32 s101, s101, 196608
  s_add_u32 s40, s38, s101
  s_add_u32 s40, s40, 1024
  s_add_u32 m0, s55, 147456
  s_nop 0
  buffer_load_dwordx4 v3, s[8:11], s40 offen lds
  s_waitcnt lgkmcnt(8)
  v_mfma_f32_32x32x16_bf16 v[16:31], v[52:55], v[164:167], v[16:31]
  ds_read_b64_tr_b16 v[76:77], v116 offset:10240
  ds_read_b64_tr_b16 v[78:79], v116 offset:10752
  s_add_u32 s40, s40, 1024
  s_add_u32 m0, s55, 155648
  s_nop 0
  buffer_load_dwordx4 v3, s[8:11], s40 offen lds
  s_waitcnt lgkmcnt(7)
  v_mfma_f32_32x32x16_bf16 v[16:31], v[56:59], v[168:171], v[16:31]
  ds_read_b64_tr_b16 v[80:81], v116 offset:12288
  ds_read_b64_tr_b16 v[82:83], v116 offset:12800
  s_waitcnt lgkmcnt(6)
  v_mfma_f32_32x32x16_bf16 v[16:31], v[60:63], v[172:175], v[16:31]
  ds_read_b64_tr_b16 v[84:85], v116 offset:14336
  ds_read_b64_tr_b16 v[86:87], v116 offset:14848
  s_waitcnt vmcnt(4)
  v_add_u32 v112, 98304, v5
  v_add_u32 v113, 98304, v6
  v_add_u32 v114, 98304, v7
  v_add_u32 v115, 98304, v8
  v_add_u32 v116, 114688, v9
  s_barrier
  v_mov_b32 v88, -1
  s_waitcnt lgkmcnt(6)
  v_mfma_f32_32x32x16_bf16 v[32:47], v[160:163], v[72:75], v[32:47]
  ds_read_b128 v[176:179], v112
  ds_read_b64_tr_b16 v[48:49], v116 offset:0
  ds_read_b64_tr_b16 v[50:51], v116 offset:512
  s_add_u32 s101, s100, 5
  s_and_b32 s101, s101, 7
  s_mul_i32 s101, s101, 128
  s_add_u32 s40, s37, s101
  s_add_u32 m0, s55, 0
  s_nop 0
  buffer_load_dwordx4 v2, s[4:7], s40 offen lds
  s_waitcnt lgkmcnt(7)
  v_mfma_f32_32x32x16_bf16 v[32:47], v[164:167], v[76:79], v[32:47]
  ds_read_b128 v[180:183], v113
  ds_read_b64_tr_b16 v[52:53], v116 offset:2048
  ds_read_b64_tr_b16 v[54:55], v116 offset:2560
  s_add_u32 s40, s40, 65536
  s_add_u32 m0, s55, 8192
  s_nop 0
  buffer_load_dwordx4 v2, s[4:7], s40 offen lds
  s_waitcnt lgkmcnt(8)
  v_mfma_f32_32x32x16_bf16 v[32:47], v[168:171], v[80:83], v[32:47]
  ds_read_b128 v[184:187], v114
  ds_read_b64_tr_b16 v[56:57], v116 offset:4096
  ds_read_b64_tr_b16 v[58:59], v116 offset:4608
  s_waitcnt lgkmcnt(9)
  v_mfma_f32_32x32x16_bf16 v[32:47], v[172:175], v[84:87], v[32:47]
  ds_read_b128 v[188:191], v115
  ds_read_b64_tr_b16 v[60:61], v116 offset:6144
  ds_read_b64_tr_b16 v[62:63], v116 offset:6656
  s_waitcnt lgkmcnt(9)
  v_mfma_f32_32x32x16_bf16 v[16:31], v[48:51], v[176:179], v[16:31]
  ds_read_b64_tr_b16 v[72:73], v116 offset:8192
  ds_read_b64_tr_b16 v[74:75], v116 offset:8704
  s_add_u32 s101, s100, 5
  s_and_b32 s101, s101, 7
  s_mul_i32 s101, s101, 196608
  s_add_u32 s40, s38, s101
  s_add_u32 s40, s40, 1024
  s_add_u32 m0, s55, 16384
  s_nop 0
  buffer_load_dwordx4 v3, s[8:11], s40 offen lds
  s_waitcnt lgkmcnt(8)
  v_mfma_f32_32x32x16_bf16 v[16:31], v[52:55], v[180:183], v[16:31]
  ds_read_b64_tr_b16 v[76:77], v116 offset:10240
  ds_read_b64_tr_b16 v[78:79], v116 offset:10752
  s_add_u32 s40, s40, 1024
  s_add_u32 m0, s55, 24576
  s_nop 0
  buffer_load_dwordx4 v3, s[8:11], s40 offen lds
  s_waitcnt lgkmcnt(7)
  v_mfma_f32_32x32x16_bf16 v[16:31], v[56:59], v[184:187], v[16:31]
  ds_read_b64_tr_b16 v[80:81], v116 offset:12288
  ds_read_b64_tr_b16 v[82:83], v116 offset:12800
  s_cmp_eq_u32 s34, 7
  s_cbranch_scc0 P0_in3
  v_lshlrev_b32 v118, 2, v1
  s_lshr_b32 s42, s32, 2
  s_lshl_b32 s42, s42, 10
  s_and_b32 s43, s32, 3
  s_lshl_b32 s43, s43, 8
  s_add_u32 s42, s42, s43
  s_add_u32 s42, s42, s53
  buffer_store_dword v88, v118, s[16:19], s42 offen sc1
  s_mov_b64 exec, -1
  s_lshr_b32 s45, s32, 2
  s_lshl_b32 s45, s45, 6
  s_and_b32 s43, s32, 3
  s_lshl_b32 s43, s43, 3
  s_add_u32 s45, s45, s43
  v_and_b32 v119, 1, v1
  v_lshlrev_b32 v119, 2, v119
  v_bfe_u32 v14, v1, 1, 1
  v_lshl_add_u32 v119, v14, 5, v119
  s_add_u32 s45, s45, s53
  s_add_u32 s45, s45, 4096
  s_mov_b64 exec, 15
  buffer_store_dword v88, v119, s[16:19], s45 offen sc1
  s_mov_b64 exec, -1
P0_in3:
  s_waitcnt lgkmcnt(6)
  v_mfma_f32_32x32x16_bf16 v[16:31], v[60:63], v[188:191], v[16:31]
  ds_read_b64_tr_b16 v[84:85], v116 offset:14336
  ds_read_b64_tr_b16 v[86:87], v116 offset:14848
  s_waitcnt vmcnt(4)
  v_add_u32 v112, 131072, v5
  v_add_u32 v113, 131072, v6
  v_add_u32 v114, 131072, v7
  v_add_u32 v115, 131072, v8
  v_add_u32 v116, 147456, v9
  s_barrier
  s_waitcnt lgkmcnt(6)
  v_mfma_f32_32x32x16_bf16 v[32:47], v[176:179], v[72:75], v[32:47]
  ds_read_b128 v[192:195], v112
  ds_read_b64_tr_b16 v[48:49], v116 offset:0
  ds_read_b64_tr_b16 v[50:51], v116 offset:512
  s_add_u32 s101, s100, 6
  s_and_b32 s101, s101, 7
  s_mul_i32 s101, s101, 128
  s_add_u32 s40, s37, s101
  s_add_u32 m0, s55, 32768
  s_nop 0
  buffer_load_dwordx4 v2, s[4:7], s40 offen lds
  s_waitcnt lgkmcnt(7)
  v_mfma_f32_32x32x16_bf16 v[32:47], v[180:183], v[76:79], v[32:47]
  ds_read_b128 v[196:199], v113
  ds_read_b64_tr_b16 v[52:53], v116 offset:2048
  ds_read_b64_tr_b16 v[54:55], v116 offset:2560
  s_add_u32 s40, s40, 65536
  s_add_u32 m0, s55, 40960
  s_nop 0
  buffer_load_dwordx4 v2, s[4:7], s40 offen lds
  s_waitcnt lgkmcnt(8)
  v_mfma_f32_32x32x16_bf16 v[32:47], v[184:187], v[80:83], v[32:47]
  ds_read_b128 v[200:203], v114
  ds_read_b64_tr_b16 v[56:57], v116 offset:4096
  ds_read_b64_tr_b16 v[58:59], v116 offset:4608
  s_waitcnt lgkmcnt(9)
  v_mfma_f32_32x32x16_bf16 v[32:47], v[188:191], v[84:87], v[32:47]
  ds_read_b128 v[204:207], v115
  ds_read_b64_tr_b16 v[60:61], v116 offset:6144
  ds_read_b64_tr_b16 v[62:63], v116 offset:6656
  s_waitcnt lgkmcnt(9)
  v_mfma_f32_32x32x16_bf16 v[16:31], v[48:51], v[192:195], v[16:31]
  ds_read_b64_tr_b16 v[72:73], v116 offset:8192
  ds_read_b64_tr_b16 v[74:75], v116 offset:8704
  s_add_u32 s101, s100, 6
  s_and_b32 s101, s101, 7
  s_mul_i32 s101, s101, 196608
  s_add_u32 s40, s38, s101
  s_add_u32 s40, s40, 1024
  s_add_u32 m0, s55, 49152
  s_nop 0
  buffer_load_dwordx4 v3, s[8:11], s40 offen lds
  s_waitcnt lgkmcnt(8)
  v_mfma_f32_32x32x16_bf16 v[16:31], v[52:55], v[196:199], v[16:31]
  ds_read_b64_tr_b16 v[76:77], v116 offset:10240
  ds_read_b64_tr_b16 v[78:79], v116 offset:10752
  s_add_u32 s40, s40, 1024
  s_add_u32 m0, s55, 57344
  s_nop 0
  buffer_load_dwordx4 v3, s[8:11], s40 offen lds
  s_waitcnt lgkmcnt(7)
  v_mfma_f32_32x32x16_bf16 v[16:31], v[56:59], v[200:203], v[16:31]
  ds_read_b64_tr_b16 v[80:81], v116 offset:12288
  ds_read_b64_tr_b16 v[82:83], v116 offset:12800
  s_waitcnt lgkmcnt(6)
  v_mfma_f32_32x32x16_bf16 v[16:31], v[60:63], v[204:207], v[16:31]
  ds_read_b64_tr_b16 v[84:85], v116 offset:14336
  ds_read_b64_tr_b16 v[86:87], v116 offset:14848
  s_waitcnt vmcnt(4)
  v_add_u32 v112, 0, v5
  v_add_u32 v113, 0, v6
  v_add_u32 v114, 0, v7
  v_add_u32 v115, 0, v8
  v_add_u32 v116, 16384, v9
  s_barrier
  s_waitcnt lgkmcnt(6)
  v_mfma_f32_32x32x16_bf16 v[32:47], v[192:195], v[72:75], v[32:47]
  ds_read_b128 v[208:211], v112
  ds_read_b64_tr_b16 v[48:49], v116 offset:0
  ds_read_b64_tr_b16 v[50:51], v116 offset:512
  s_add_u32 s101, s100, 7
  s_and_b32 s101, s101, 7
  s_mul_i32 s101, s101, 128
  s_add_u32 s40, s37, s101
  s_add_u32 m0, s55, 65536
  s_nop 0
  buffer_load_dwordx4 v2, s[4:7], s40 offen lds
  s_waitcnt lgkmcnt(7)
  v_mfma_f32_32x32x16_bf16 v[32:47], v[196:199], v[76:79], v[32:47]
  ds_read_b128 v[212:215], v113
  ds_read_b64_tr_b16 v[52:53], v116 offset:2048
  ds_read_b64_tr_b16 v[54:55], v116 offset:2560
  s_add_u32 s40, s40, 65536
  s_add_u32 m0, s55, 73728
  s_nop 0
  buffer_load_dwordx4 v2, s[4:7], s40 offen lds
  s_waitcnt lgkmcnt(8)
  v_mfma_f32_32x32x16_bf16 v[32:47], v[200:203], v[80:83], v[32:47]
  ds_read_b128 v[216:219], v114
  ds_read_b64_tr_b16 v[56:57], v116 offset:4096
  ds_read_b64_tr_b16 v[58:59], v116 offset:4608
  s_waitcnt lgkmcnt(9)
  v_mfma_f32_32x32x16_bf16 v[32:47], v[204:207], v[84:87], v[32:47]
  ds_read_b128 v[220:223], v115
  ds_read_b64_tr_b16 v[60:61], v116 offset:6144
  ds_read_b64_tr_b16 v[62:63], v116 offset:6656
  s_waitcnt lgkmcnt(9)
  v_mfma_f32_32x32x16_bf16 v[16:31], v[48:51], v[208:211], v[16:31]
  ds_read_b64_tr_b16 v[72:73], v116 offset:8192
  ds_read_b64_tr_b16 v[74:75], v116 offset:8704
  s_add_u32 s101, s100, 7
  s_and_b32 s101, s101, 7
  s_mul_i32 s101, s101, 196608
  s_add_u32 s40, s38, s101
  s_add_u32 s40, s40, 1024
  s_add_u32 m0, s55, 81920
  s_nop 0
  buffer_load_dwordx4 v3, s[8:11], s40 offen lds
  s_waitcnt lgkmcnt(8)
  v_mfma_f32_32x32x16_bf16 v[16:31], v[52:55], v[212:215], v[16:31]
  ds_read_b64_tr_b16 v[76:77], v116 offset:10240
  ds_read_b64_tr_b16 v[78:79], v116 offset:10752
  s_add_u32 s40, s40, 1024
  s_add_u32 m0, s55, 90112
  s_nop 0
  buffer_load_dwordx4 v3, s[8:11], s40 offen lds
  s_waitcnt lgkmcnt(7)
  v_mfma_f32_32x32x16_bf16 v[16:31], v[56:59], v[216:219], v[16:31]
  ds_read_b64_tr_b16 v[80:81], v116 offset:12288
  ds_read_b64_tr_b16 v[82:83], v116 offset:12800
  s_waitcnt lgkmcnt(6)
  v_mfma_f32_32x32x16_bf16 v[16:31], v[60:63], v[220:223], v[16:31]
  ds_read_b64_tr_b16 v[84:85], v116 offset:14336
  ds_read_b64_tr_b16 v[86:87], v116 offset:14848
  s_waitcnt vmcnt(4)
  v_add_u32 v112, 32768, v5
  v_add_u32 v113, 32768, v6
  v_add_u32 v114, 32768, v7
  v_add_u32 v115, 32768, v8
  v_add_u32 v116, 49152, v9
  s_barrier
  s_waitcnt lgkmcnt(6)
  v_mfma_f32_32x32x16_bf16 v[32:47], v[208:211], v[72:75], v[32:47]
  ds_read_b128 v[224:227], v112
  ds_read_b64_tr_b16 v[48:49], v116 offset:0
  ds_read_b64_tr_b16 v[50:51], v116 offset:512
  s_add_u32 s101, s100, 0
  s_and_b32 s101, s101, 7
  s_mul_i32 s101, s101, 196608
  s_add_u32 s40, s38, s101
  s_add_u32 m0, s55, 98304
  s_nop 0
  buffer_load_dwordx4 v3, s[8:11], s40 offen lds
  s_waitcnt lgkmcnt(7)
  v_mfma_f32_32x32x16_bf16 v[32:47], v[212:215], v[76:79], v[32:47]
  ds_read_b128 v[228:231], v113
  ds_read_b64_tr_b16 v[52:53], v116 offset:2048
  ds_read_b64_tr_b16 v[54:55], v116 offset:2560
  s_add_u32 s101, s100, 1
  s_and_b32 s101, s101, 7
  s_mul_i32 s101, s101, 196608
  s_add_u32 s40, s38, s101
  s_add_u32 m0, s55, 106496
  s_nop 0
  buffer_load_dwordx4 v3, s[8:11], s40 offen lds
  s_waitcnt lgkmcnt(8)
  v_mfma_f32_32x32x16_bf16 v[32:47], v[216:219], v[80:83], v[32:47]
  ds_read_b128 v[232:235], v114
  ds_read_b64_tr_b16 v[56:57], v116 offset:4096
  ds_read_b64_tr_b16 v[58:59], v116 offset:4608
  s_waitcnt lgkmcnt(9)
  v_mfma_f32_32x32x16_bf16 v[32:47], v[220:223], v[84:87], v[32:47]
  ds_read_b128 v[236:239], v115
  ds_read_b64_tr_b16 v[60:61], v116 offset:6144
  ds_read_b64_tr_b16 v[62:63], v116 offset:6656
  s_waitcnt lgkmcnt(9)
  v_mfma_f32_32x32x16_bf16 v[16:31], v[48:51], v[224:227], v[16:31]
  ds_read_b64_tr_b16 v[72:73], v116 offset:8192
  ds_read_b64_tr_b16 v[74:75], v116 offset:8704
  s_add_u32 s101, s100, 2
  s_and_b32 s101, s101, 7
  s_mul_i32 s101, s101, 196608
  s_add_u32 s40, s38, s101
  s_add_u32 m0, s55, 114688
  s_nop 0
  buffer_load_dwordx4 v3, s[8:11], s40 offen lds
  s_waitcnt lgkmcnt(8)
  v_mfma_f32_32x32x16_bf16 v[16:31], v[52:55], v[228:231], v[16:31]
  ds_read_b64_tr_b16 v[76:77], v116 offset:10240
  ds_read_b64_tr_b16 v[78:79], v116 offset:10752
  s_add_u32 s101, s100, 3
  s_and_b32 s101, s101, 7
  s_mul_i32 s101, s101, 196608
  s_add_u32 s40, s38, s101
  s_add_u32 m0, s55, 122880
  s_nop 0
  buffer_load_dwordx4 v3, s[8:11], s40 offen lds
  s_waitcnt lgkmcnt(7)
  v_mfma_f32_32x32x16_bf16 v[16:31], v[56:59], v[232:235], v[16:31]
  ds_read_b64_tr_b16 v[80:81], v116 offset:12288
  ds_read_b64_tr_b16 v[82:83], v116 offset:12800
  s_waitcnt lgkmcnt(6)
  v_mfma_f32_32x32x16_bf16 v[16:31], v[60:63], v[236:239], v[16:31]
  ds_read_b64_tr_b16 v[84:85], v116 offset:14336
  ds_read_b64_tr_b16 v[86:87], v116 offset:14848
  s_waitcnt vmcnt(4)
  v_add_u32 v112, 65536, v5
  v_add_u32 v113, 65536, v6
  v_add_u32 v114, 65536, v7
  v_add_u32 v115, 65536, v8
  v_add_u32 v116, 81920, v9
  s_barrier
  s_waitcnt lgkmcnt(6)
  v_mfma_f32_32x32x16_bf16 v[32:47], v[224:227], v[72:75], v[32:47]
  ds_read_b128 v[240:243], v112
  ds_read_b64_tr_b16 v[48:49], v116 offset:0
  ds_read_b64_tr_b16 v[50:51], v116 offset:512
  s_add_u32 s101, s100, 4
  s_and_b32 s101, s101, 7
  s_mul_i32 s101, s101, 196608
  s_add_u32 s40, s38, s101
  s_add_u32 m0, s55, 131072
  s_nop 0
  buffer_load_dwordx4 v3, s[8:11], s40 offen lds
  s_waitcnt lgkmcnt(7)
  v_mfma_f32_32x32x16_bf16 v[32:47], v[228:231], v[76:79], v[32:47]
  ds_read_b128 v[244:247], v113
  ds_read_b64_tr_b16 v[52:53], v116 offset:2048
  ds_read_b64_tr_b16 v[54:55], v116 offset:2560
  s_add_u32 s101, s100, 5
  s_and_b32 s101, s101, 7
  s_mul_i32 s101, s101, 196608
  s_add_u32 s40, s38, s101
  s_add_u32 m0, s55, 139264
  s_nop 0
  buffer_load_dwordx4 v3, s[8:11], s40 offen lds
  s_waitcnt lgkmcnt(8)
  v_mfma_f32_32x32x16_bf16 v[32:47], v[232:235], v[80:83], v[32:47]
  ds_read_b128 v[248:251], v114
  ds_read_b64_tr_b16 v[56:57], v116 offset:4096
  ds_read_b64_tr_b16 v[58:59], v116 offset:4608
  s_waitcnt lgkmcnt(9)
  v_mfma_f32_32x32x16_bf16 v[32:47], v[236:239], v[84:87], v[32:47]
  ds_read_b128 v[252:255], v115
  ds_read_b64_tr_b16 v[60:61], v116 offset:6144
  ds_read_b64_tr_b16 v[62:63], v116 offset:6656
  s_waitcnt lgkmcnt(9)
  v_mfma_f32_32x32x16_bf16 v[16:31], v[48:51], v[240:243], v[16:31]
  ds_read_b64_tr_b16 v[72:73], v116 offset:8192
  ds_read_b64_tr_b16 v[74:75], v116 offset:8704
  s_add_u32 s101, s100, 6
  s_and_b32 s101, s101, 7
  s_mul_i32 s101, s101, 196608
  s_add_u32 s40, s38, s101
  s_add_u32 m0, s55, 147456
  s_nop 0
  buffer_load_dwordx4 v3, s[8:11], s40 offen lds
  s_waitcnt lgkmcnt(8)
  v_mfma_f32_32x32x16_bf16 v[16:31], v[52:55], v[244:247], v[16:31]
  ds_read_b64_tr_b16 v[76:77], v116 offset:10240
  ds_read_b64_tr_b16 v[78:79], v116 offset:10752
  s_add_u32 s101, s100, 7
  s_and_b32 s101, s101, 7
  s_mul_i32 s101, s101, 196608
  s_add_u32 s40, s38, s101
  s_add_u32 m0, s55, 155648
  s_nop 0
  buffer_load_dwordx4 v3, s[8:11], s40 offen lds
  s_waitcnt lgkmcnt(7)
  v_mfma_f32_32x32x16_bf16 v[16:31], v[56:59], v[248:251], v[16:31]
  ds_read_b64_tr_b16 v[80:81], v116 offset:12288
  ds_read_b64_tr_b16 v[82:83], v116 offset:12800
  s_waitcnt lgkmcnt(6)
  v_mfma_f32_32x32x16_bf16 v[16:31], v[60:63], v[252:255], v[16:31]
  ds_read_b64_tr_b16 v[84:85], v116 offset:14336
  ds_read_b64_tr_b16 v[86:87], v116 offset:14848
  v_lshrrev_b32 v0, 2, v1
  v_mul_u32_u24 v0, 9216, v0
  v_mov_b32 v117, v0
  v_and_b32 v14, 1, v1
  v_lshlrev_b32 v2, 4, v14
  v_add_u32 v0, v0, v2
  v_mov_b32 v117, v0
  v_bfe_u32 v14, v1, 1, 1
  v_lshl_add_u32 v0, v14, 10, v0
  v_lshl_add_u32 v2, v14, 3, v2
  v_and_b32 v124, 15, v1
  s_lshl_b32 s41, s33, 4
  v_add_u32 v124, s41, v124
  v_and_b32 v14, 7, v1
  v_lshlrev_b32 v14, 4, v14
  v_add_u32 v14, s32, v14
  s_mov_b64 exec, s[48:49]
  v_mov_b32 v124, v14
  s_mov_b64 exec, -1
  v_lshlrev_b32 v124, 7, v124
  s_lshl_b32 s41, s36, 14
  v_add_u32 v120, s41, v10
  v_xor_b32 v121, 16, v120
  v_xor_b32 v122, 32, v120
  v_xor_b32 v123, 48, v120
  v_add_u32 v112, s70, v11
  v_add_u32 v113, s70, v12
  v_add_u32 v114, s71, v13
  s_bfe_u32 s41, s25, 0x80000
  v_mov_b32 v5, s41
  s_bfe_u32 s41, s25, 0x80008
  v_mov_b32 v6, s41
  s_bfe_u32 s41, s25, 0x80010
  v_mov_b32 v7, s41
  s_bfe_u32 s41, s25, 0x80018
  v_mov_b32 v8, s41
  v_and_b32 v14, 3, v1
  v_lshlrev_b32 v14, 3, v14
  v_mov_b32 v116, s25
  v_lshrrev_b32 v116, v14, v116
  v_and_b32 v116, 0xff, v116
  v_lshrrev_b32 v3, 5, v1
  v_lshlrev_b32 v3, 5, v3
  v_bfe_u32 v14, v1, 4, 1
  v_xor_b32 v14, 1, v14
  v_lshl_add_u32 v3, v14, 6, v3
  s_waitcnt lgkmcnt(6)
  v_mfma_f32_32x32x16_bf16 v[32:47], v[240:243], v[72:75], v[32:47]
  s_waitcnt lgkmcnt(4)
  v_mfma_f32_32x32x16_bf16 v[32:47], v[244:247], v[76:79], v[32:47]
  s_waitcnt lgkmcnt(2)
  v_mfma_f32_32x32x16_bf16 v[32:47], v[248:251], v[80:83], v[32:47]
  s_waitcnt lgkmcnt(0)
  v_mfma_f32_32x32x16_bf16 v[32:47], v[252:255], v[84:87], v[32:47]
  s_barrier
  s_cmp_eq_u32 s34, 0
  s_cbranch_scc0 P0_fl4
  s_lshl_b32 s42, s33, 4
  s_add_u32 s42, s42, s32
  s_lshl_b32 s42, s42, 7
  s_add_u32 s42, s42, 4096
  v_mov_b32 v14, 0
  v_mov_b32 v15, s54
  s_mov_b64 exec, 1
  buffer_store_dword v15, v14, s[16:19], s42 offen sc1
  s_mov_b64 exec, -1
P0_fl4:
  v_cvt_pk_bf16_f32 v64, v16, v17
  s_add_u32 m0, s55, 49152
  s_add_u32 s40, s81, 32768
  buffer_load_dwordx4 v4, s[12:15], s81 offen lds
  s_add_u32 m0, s55, 57344
  s_nop 0
  buffer_load_dwordx4 v4, s[12:15], s40 offen lds
  v_cvt_pk_bf16_f32 v65, v18, v19
  v_cvt_pk_bf16_f32 v66, v20, v21
  v_cvt_pk_bf16_f32 v67, v22, v23
  v_cvt_pk_bf16_f32 v68, v24, v25
  v_cvt_pk_bf16_f32 v69, v26, v27
  v_cvt_pk_bf16_f32 v70, v28, v29
  v_cvt_pk_bf16_f32 v71, v30, v31
  v_mfma_f32_32x32x16_bf16 v[72:87], v[104:107], v[64:67], 0
  s_nop 0
  v_mfma_f32_32x32x16_bf16 v[72:87], v[108:111], v[68:71], v[72:87]
  s_nop 11
  v_max3_f32 v64, v72, v73, v74
  v_min3_f32 v65, v72, v73, v74
  v_max3_f32 v66, v75, v76, v77
  v_min3_f32 v67, v75, v76, v77
  v_max3_f32 v68, v80, v81, v82
  v_min3_f32 v69, v80, v81, v82
  v_max3_f32 v70, v83, v84, v85
  v_min3_f32 v71, v83, v84, v85
  v_max3_f32 v64, v64, v78, v79
  v_min3_f32 v65, v65, v78, v79
  v_max3_f32 v68, v68, v86, v87
  v_min3_f32 v69, v69, v86, v87
  v_max_f32 v64, v64, v66
  v_min_f32 v65, v65, v67
  v_max_f32 v68, v68, v70
  v_min_f32 v69, v69, v71
  v_mul_f32 v64, 0xbfb8aa3b, v64
  v_mul_f32 v68, 0xbfb8aa3b, v68
  v_mul_f32 v65, v126, v65
  v_mul_f32 v69, v126, v69
  s_nop 0
  v_permlane32_swap_b32 v64, v65
  v_permlane32_swap_b32 v68, v69
  v_min_f32 v64, v64, v65
  v_min_f32 v68, v68, v69
  v_mov_b32 v65, v64
  v_mov_b32 v69, v68
  s_nop 0
  v_permlane32_swap_b32 v64, v65
  v_permlane32_swap_b32 v68, v69
  v_fmamk_f32 v88, v72, 0x3fb8aa3b, v64
  v_fmamk_f32 v72, v72, 0xbfb8aa3b, v65
  v_fmamk_f32 v89, v73, 0x3fb8aa3b, v64
  v_fmamk_f32 v73, v73, 0xbfb8aa3b, v65
  v_fmamk_f32 v90, v74, 0x3fb8aa3b, v64
  v_fmamk_f32 v74, v74, 0xbfb8aa3b, v65
  v_fmamk_f32 v91, v75, 0x3fb8aa3b, v64
  v_fmamk_f32 v75, v75, 0xbfb8aa3b, v65
  v_fmamk_f32 v92, v76, 0x3fb8aa3b, v64
  v_fmamk_f32 v76, v76, 0xbfb8aa3b, v65
  v_fmamk_f32 v93, v77, 0x3fb8aa3b, v64
  v_fmamk_f32 v77, v77, 0xbfb8aa3b, v65
  v_fmamk_f32 v94, v78, 0x3fb8aa3b, v64
  v_fmamk_f32 v78, v78, 0xbfb8aa3b, v65
  v_fmamk_f32 v95, v79, 0x3fb8aa3b, v64
  s_add_u32 m0, s55, 65536
  s_add_u32 s40, s82, 32768
  buffer_load_dwordx4 v4, s[12:15], s82 offen lds
  s_add_u32 m0, s55, 73728
  s_nop 0
  buffer_load_dwordx4 v4, s[12:15], s40 offen lds
  v_fmamk_f32 v79, v79, 0xbfb8aa3b, v65
  v_fmamk_f32 v96, v80, 0x3fb8aa3b, v68
  v_fmamk_f32 v80, v80, 0xbfb8aa3b, v69
  v_fmamk_f32 v97, v81, 0x3fb8aa3b, v68
  v_fmamk_f32 v81, v81, 0xbfb8aa3b, v69
  v_fmamk_f32 v98, v82, 0x3fb8aa3b, v68
  v_fmamk_f32 v82, v82, 0xbfb8aa3b, v69
  v_fmamk_f32 v99, v83, 0x3fb8aa3b, v68
  v_fmamk_f32 v83, v83, 0xbfb8aa3b, v69
  v_fmamk_f32 v100, v84, 0x3fb8aa3b, v68
  v_fmamk_f32 v84, v84, 0xbfb8aa3b, v69
  v_fmamk_f32 v101, v85, 0x3fb8aa3b, v68
  v_fmamk_f32 v85, v85, 0xbfb8aa3b, v69
  v_fmamk_f32 v102, v86, 0x3fb8aa3b, v68
  v_fmamk_f32 v86, v86, 0xbfb8aa3b, v69
  v_fmamk_f32 v103, v87, 0x3fb8aa3b, v68
  v_fmamk_f32 v87, v87, 0xbfb8aa3b, v69
  v_exp_f32 v88, v88
  v_exp_f32 v72, v72
  v_exp_f32 v89, v89
  v_exp_f32 v73, v73
  v_exp_f32 v90, v90
  v_exp_f32 v74, v74
  v_exp_f32 v91, v91
  v_exp_f32 v75, v75
  v_exp_f32 v92, v92
  v_exp_f32 v76, v76
  v_exp_f32 v93, v93
  v_exp_f32 v77, v77
  v_exp_f32 v94, v94
  v_exp_f32 v78, v78
  v_exp_f32 v95, v95
  v_exp_f32 v79, v79
  v_exp_f32 v96, v96
  v_exp_f32 v80, v80
  v_exp_f32 v97, v97
  v_exp_f32 v81, v81
  v_exp_f32 v98, v98
  v_exp_f32 v82, v82
  v_exp_f32 v99, v99
  v_exp_f32 v83, v83
  v_exp_f32 v100, v100
  v_exp_f32 v84, v84
  v_exp_f32 v101, v101
  v_exp_f32 v85, v85
  v_exp_f32 v102, v102
  v_exp_f32 v86, v86
  v_exp_f32 v103, v103
  v_exp_f32 v87, v87
  v_add_f32 v64, v88, v89
  v_add_f32 v65, v72, v73
  v_add_f32 v66, v90, v91
  s_add_u32 m0, s55, 81920
  s_add_u32 s40, s83, 32768
  buffer_load_dwordx4 v4, s[12:15], s83 offen lds
  s_add_u32 m0, s55, 90112
  s_nop 0
  buffer_load_dwordx4 v4, s[12:15], s40 offen lds
  v_add_f32 v67, v74, v75
  v_add_f32 v64, v64, v92
  v_add_f32 v65, v65, v76
  v_add_f32 v66, v66, v93
  v_add_f32 v67, v67, v77
  v_add_f32 v64, v64, v94
  v_add_f32 v65, v65, v78
  v_add_f32 v66, v66, v95
  v_add_f32 v67, v67, v79
  v_add_f32 v64, v64, v66
  v_add_f32 v65, v65, v67
  v_add_f32 v68, v96, v97
  v_add_f32 v69, v80, v81
  v_add_f32 v70, v98, v99
  v_add_f32 v71, v82, v83
  v_add_f32 v68, v68, v100
  v_add_f32 v69, v69, v84
  v_add_f32 v70, v70, v101
  v_add_f32 v71, v71, v85
  v_add_f32 v68, v68, v102
  v_add_f32 v69, v69, v86
  v_add_f32 v70, v70, v103
  v_add_f32 v71, v71, v87
  v_add_f32 v68, v68, v70
  v_add_f32 v69, v69, v71
  v_permlane32_swap_b32 v64, v65
  s_nop 0
  v_permlane32_swap_b32 v68, v69
  v_add_f32 v64, v64, v65
  v_add_f32 v68, v68, v69
  v_rcp_f32 v64, v64
  v_rcp_f32 v68, v68
  v_mov_b32 v65, v64
  v_mov_b32 v69, v68
  s_nop 0
  v_permlane32_swap_b32 v64, v65
  v_permlane32_swap_b32 v68, v69
  v_mul_f32 v88, v88, v64
  v_mul_f32 v72, v72, v65
  v_mul_f32 v89, v89, v64
  v_mul_f32 v73, v73, v65
  v_mul_f32 v90, v90, v64
  v_mul_f32 v74, v74, v65
  v_mul_f32 v91, v91, v64
  v_mul_f32 v75, v75, v65
  v_mul_f32 v92, v92, v64
  v_mul_f32 v76, v76, v65
  v_mul_f32 v93, v93, v64
  v_mul_f32 v77, v77, v65
  v_mul_f32 v94, v94, v64
  v_mul_f32 v78, v78, v65
  v_mul_f32 v95, v95, v64
  v_mul_f32 v79, v79, v65
  v_cvt_pk_bf16_f32 v16, v88, v89
  v_cvt_pk_bf16_f32 v17, v90, v91
  v_cvt_pk_bf16_f32 v18, v92, v93
  v_cvt_pk_bf16_f32 v19, v94, v95
  v_cvt_pk_bf16_f32 v20, v72, v73
  v_cvt_pk_bf16_f32 v21, v74, v75
  v_cvt_pk_bf16_f32 v22, v76, v77
  v_cvt_pk_bf16_f32 v23, v78, v79
  v_mul_f32 v96, v96, v68
  v_mul_f32 v80, v80, v69
  v_mul_f32 v97, v97, v68
  v_mul_f32 v81, v81, v69
  v_mul_f32 v98, v98, v68
  v_mul_f32 v82, v82, v69
  v_mul_f32 v99, v99, v68
  v_mul_f32 v83, v83, v69
  v_mul_f32 v100, v100, v68
  v_mul_f32 v84, v84, v69
  v_mul_f32 v101, v101, v68
  v_mul_f32 v85, v85, v69
  v_mul_f32 v102, v102, v68
  v_mul_f32 v86, v86, v69
  v_mul_f32 v103, v103, v68
  v_mul_f32 v87, v87, v69
  v_cvt_pk_bf16_f32 v24, v96, v97
  v_cvt_pk_bf16_f32 v25, v98, v99
  v_cvt_pk_bf16_f32 v26, v100, v101
  v_cvt_pk_bf16_f32 v27, v102, v103
  v_cvt_pk_bf16_f32 v28, v80, v81
  v_cvt_pk_bf16_f32 v29, v82, v83
  v_cvt_pk_bf16_f32 v30, v84, v85
  v_cvt_pk_bf16_f32 v31, v86, v87
  ds_write_b64 v120, v[16:17] offset:0
  ds_write_b64 v121, v[18:19] offset:0
  ds_write_b64 v122, v[20:21] offset:0
  ds_write_b64 v123, v[22:23] offset:0
  ds_write_b64 v120, v[24:25] offset:8192
  ds_write_b64 v121, v[26:27] offset:8192
  ds_write_b64 v122, v[28:29] offset:8192
  ds_write_b64 v123, v[30:31] offset:8192
  v_cvt_pk_bf16_f32 v48, v32, v33
  v_cvt_pk_bf16_f32 v49, v34, v35
  v_cvt_pk_bf16_f32 v50, v36, v37
  v_cvt_pk_bf16_f32 v51, v38, v39
  v_cvt_pk_bf16_f32 v52, v40, v41
  v_cvt_pk_bf16_f32 v53, v42, v43
  v_cvt_pk_bf16_f32 v54, v44, v45
  v_cvt_pk_bf16_f32 v55, v46, v47
  s_lshl_b32 s41, s34, 11
  v_add_u32 v115, s41, v13
  v_add_u32 v115, 32768, v115
  ds_write_b128 v115, v[48:51]
  ds_write_b128 v115, v[52:55] offset:1024
  s_waitcnt lgkmcnt(0)
  s_barrier
  s_bitcmp1_b32 s34, 2
  s_cbranch_scc1 P0_kz5
  ds_read_b64_tr_b16 v[72:73], v112 offset:0
  ds_read_b64_tr_b16 v[74:75], v113 offset:0
  ds_read_b128 v[88:91], v114 offset:0
  ds_read_b64_tr_b16 v[76:77], v112 offset:1024
  ds_read_b64_tr_b16 v[78:79], v113 offset:1024
  ds_read_b128 v[92:95], v114 offset:1024
  ds_read_b64_tr_b16 v[80:81], v112 offset:2048
  ds_read_b64_tr_b16 v[82:83], v113 offset:2048
  ds_read_b128 v[96:99], v114 offset:2048
  ds_read_b64_tr_b16 v[84:85], v112 offset:3072
  ds_read_b64_tr_b16 v[86:87], v113 offset:3072
  ds_read_b128 v[100:103], v114 offset:3072
  ds_read_b64_tr_b16 v[16:17], v112 offset:4096
  ds_read_b64_tr_b16 v[18:19], v113 offset:4096
  ds_read_b128 v[48:51], v114 offset:4096
  s_waitcnt lgkmcnt(12)
  v_mfma_f32_32x32x16_bf16 v[32:47], v[72:75], v[88:91], 0
  ds_read_b64_tr_b16 v[20:21], v112 offset:5120
  ds_read_b64_tr_b16 v[22:23], v113 offset:5120
  ds_read_b128 v[52:55], v114 offset:5120
  s_waitcnt lgkmcnt(12)
  v_mfma_f32_32x32x16_bf16 v[32:47], v[76:79], v[92:95], v[32:47]
  ds_read_b64_tr_b16 v[24:25], v112 offset:6144
  ds_read_b64_tr_b16 v[26:27], v113 offset:6144
  ds_read_b128 v[56:59], v114 offset:6144
  s_waitcnt lgkmcnt(12)
  v_mfma_f32_32x32x16_bf16 v[32:47], v[80:83], v[96:99], v[32:47]
  ds_read_b64_tr_b16 v[28:29], v112 offset:7168
  ds_read_b64_tr_b16 v[30:31], v113 offset:7168
  ds_read_b128 v[60:63], v114 offset:7168
  s_waitcnt lgkmcnt(12)
  v_mfma_f32_32x32x16_bf16 v[32:47], v[84:87], v[100:103], v[32:47]
  s_waitcnt lgkmcnt(9)
  v_mfma_f32_32x32x16_bf16 v[32:47], v[16:19], v[48:51], v[32:47]
  s_waitcnt lgkmcnt(6)
  v_mfma_f32_32x32x16_bf16 v[32:47], v[20:23], v[52:55], v[32:47]
  s_waitcnt lgkmcnt(3)
  v_mfma_f32_32x32x16_bf16 v[32:47], v[24:27], v[56:59], v[32:47]
  s_waitcnt lgkmcnt(0)
  v_mfma_f32_32x32x16_bf16 v[32:47], v[28:31], v[60:63], v[32:47]
  s_branch P0_kj6
P0_kz5:
  v_mov_b32 v88, 0x3f803f80
  v_mov_b32 v89, 0x3f803f80
  v_mov_b32 v90, 0x3f803f80
  v_mov_b32 v91, 0x3f803f80
  ds_read_b64_tr_b16 v[72:73], v112 offset:0
  ds_read_b64_tr_b16 v[74:75], v113 offset:0
  ds_read_b64_tr_b16 v[76:77], v112 offset:1024
  ds_read_b64_tr_b16 v[78:79], v113 offset:1024
  ds_read_b64_tr_b16 v[80:81], v112 offset:2048
  ds_read_b64_tr_b16 v[82:83], v113 offset:2048
  ds_read_b64_tr_b16 v[84:85], v112 offset:3072
  ds_read_b64_tr_b16 v[86:87], v113 offset:3072
  ds_read_b64_tr_b16 v[16:17], v112 offset:4096
  ds_read_b64_tr_b16 v[18:19], v113 offset:4096
  ds_read_b64_tr_b16 v[20:21], v112 offset:5120
  ds_read_b64_tr_b16 v[22:23], v113 offset:5120
  ds_read_b64_tr_b16 v[24:25], v112 offset:6144
  ds_read_b64_tr_b16 v[26:27], v113 offset:6144
  ds_read_b64_tr_b16 v[28:29], v112 offset:7168
  ds_read_b64_tr_b16 v[30:31], v113 offset:7168
  s_waitcnt lgkmcnt(14)
  v_mfma_f32_32x32x16_bf16 v[32:47], v[88:91], v[72:75], 0
  s_waitcnt lgkmcnt(12)
  v_mfma_f32_32x32x16_bf16 v[32:47], v[88:91], v[76:79], v[32:47]
  s_waitcnt lgkmcnt(10)
  v_mfma_f32_32x32x16_bf16 v[32:47], v[88:91], v[80:83], v[32:47]
  s_waitcnt lgkmcnt(8)
  v_mfma_f32_32x32x16_bf16 v[32:47], v[88:91], v[84:87], v[32:47]
  s_waitcnt lgkmcnt(6)
  v_mfma_f32_32x32x16_bf16 v[32:47], v[88:91], v[16:19], v[32:47]
  s_waitcnt lgkmcnt(4)
  v_mfma_f32_32x32x16_bf16 v[32:47], v[88:91], v[20:23], v[32:47]
  s_waitcnt lgkmcnt(2)
  v_mfma_f32_32x32x16_bf16 v[32:47], v[88:91], v[24:27], v[32:47]
  s_waitcnt lgkmcnt(0)
  v_mfma_f32_32x32x16_bf16 v[32:47], v[88:91], v[28:31], v[32:47]
P0_kj6:
  s_nop 11
  s_nop 1
  s_bitcmp1_b32 s34, 2
  s_cbranch_scc1 P0_pz7
  v_permlane16_swap_b32 v32, v40
  v_permlane16_swap_b32 v33, v41
  v_permlane16_swap_b32 v34, v42
  v_permlane16_swap_b32 v35, v43
  v_permlane16_swap_b32 v36, v44
  v_permlane16_swap_b32 v37, v45
  v_permlane16_swap_b32 v38, v46
  v_permlane16_swap_b32 v39, v47
  s_mov_b32 s42, s69
  s_bitcmp1_b32 s34, 1
  s_cbranch_scc1 P0_pk9
  s_mov_b32 s44, 0xffffff00
  v_and_or_b32 v32, v32, s44, v5
  v_and_or_b32 v33, v33, s44, v6
  v_and_or_b32 v34, v34, s44, v7
  v_and_or_b32 v35, v35, s44, v8
  v_and_or_b32 v36, v36, s44, v5
  v_and_or_b32 v37, v37, s44, v6
  v_and_or_b32 v38, v38, s44, v7
  v_and_or_b32 v39, v39, s44, v8
  buffer_store_dwordx4 v[32:35], v13, s[16:19], s42 offen offset:0 sc1
  buffer_store_dwordx4 v[36:39], v13, s[16:19], s42 offen offset:1024 sc1
  s_branch P0_pj8
P0_pk9:
  s_mov_b32 s44, 0xffffff00
  v_and_or_b32 v40, v40, s44, v5
  v_and_or_b32 v41, v41, s44, v6
  v_and_or_b32 v42, v42, s44, v7
  v_and_or_b32 v43, v43, s44, v8
  v_and_or_b32 v44, v44, s44, v5
  v_and_or_b32 v45, v45, s44, v6
  v_and_or_b32 v46, v46, s44, v7
  v_and_or_b32 v47, v47, s44, v8
  buffer_store_dwordx4 v[40:43], v13, s[16:19], s42 offen offset:0 sc1
  buffer_store_dwordx4 v[44:47], v13, s[16:19], s42 offen offset:1024 sc1
  s_branch P0_pj8
P0_pz7:
  s_mov_b32 s42, s69
  s_mov_b32 s44, 0xffffff00
  v_and_or_b32 v32, v32, s44, v116
  v_lshlrev_b32 v112, 2, v1
  s_mov_b32 exec_lo, -1
  s_mov_b32 exec_hi, 0
  buffer_store_dword v32, v112, s[16:19], s42 offen sc1
  s_mov_b64 exec, -1
P0_pj8:
  v_add_u32 v114, 98304, v9
  s_waitcnt vmcnt(6)
  s_barrier
  ds_read_b64_tr_b16 v[48:49], v114 offset:0
  ds_read_b64_tr_b16 v[50:51], v114 offset:512
  ds_read_b64_tr_b16 v[52:53], v114 offset:2048
  ds_read_b64_tr_b16 v[54:55], v114 offset:2560
  s_waitcnt lgkmcnt(2)
  v_mfma_f32_32x32x16_bf16 v[16:31], v[48:51], v[128:131], 0
  ds_read_b64_tr_b16 v[56:57], v114 offset:4096
  ds_read_b64_tr_b16 v[58:59], v114 offset:4608
  s_waitcnt lgkmcnt(2)
  v_mfma_f32_32x32x16_bf16 v[16:31], v[52:55], v[132:135], v[16:31]
  ds_read_b64_tr_b16 v[60:61], v114 offset:6144
  ds_read_b64_tr_b16 v[62:63], v114 offset:6656
  s_mov_b32 s41, 4096
  buffer_load_dword v125, v124, s[16:19], s41 offen sc1
  s_waitcnt lgkmcnt(2)
  v_mfma_f32_32x32x16_bf16 v[16:31], v[56:59], v[136:139], v[16:31]
  ds_read_b64_tr_b16 v[48:49], v114 offset:8192
  ds_read_b64_tr_b16 v[50:51], v114 offset:8704
  s_waitcnt lgkmcnt(2)
  v_mfma_f32_32x32x16_bf16 v[16:31], v[60:63], v[140:143], v[16:31]
  ds_read_b64_tr_b16 v[52:53], v114 offset:10240
  ds_read_b64_tr_b16 v[54:55], v114 offset:10752
  s_waitcnt lgkmcnt(2)
  v_mfma_f32_32x32x16_bf16 v[16:31], v[48:51], v[144:147], v[16:31]
  ds_read_b64_tr_b16 v[56:57], v114 offset:12288
  ds_read_b64_tr_b16 v[58:59], v114 offset:12800
  s_waitcnt lgkmcnt(2)
  v_mfma_f32_32x32x16_bf16 v[16:31], v[52:55], v[148:151], v[16:31]
  ds_read_b64_tr_b16 v[60:61], v114 offset:14336
  ds_read_b64_tr_b16 v[62:63], v114 offset:14848
  s_waitcnt lgkmcnt(2)
  v_mfma_f32_32x32x16_bf16 v[16:31], v[56:59], v[152:155], v[16:31]
  ds_read_b64_tr_b16 v[48:49], v114 offset:16384
  ds_read_b64_tr_b16 v[50:51], v114 offset:16896
  s_waitcnt lgkmcnt(2)
  v_mfma_f32_32x32x16_bf16 v[16:31], v[60:63], v[156:159], v[16:31]
  ds_read_b64_tr_b16 v[52:53], v114 offset:18432
  ds_read_b64_tr_b16 v[54:55], v114 offset:18944
  s_waitcnt lgkmcnt(2)
  v_mfma_f32_32x32x16_bf16 v[16:31], v[48:51], v[160:163], v[16:31]
  ds_read_b64_tr_b16 v[56:57], v114 offset:20480
  ds_read_b64_tr_b16 v[58:59], v114 offset:20992
  s_waitcnt lgkmcnt(2)
  v_mfma_f32_32x32x16_bf16 v[16:31], v[52:55], v[164:167], v[16:31]
  ds_read_b64_tr_b16 v[60:61], v114 offset:22528
  ds_read_b64_tr_b16 v[62:63], v114 offset:23040
  s_waitcnt lgkmcnt(2)
  v_mfma_f32_32x32x16_bf16 v[16:31], v[56:59], v[168:171], v[16:31]
  ds_read_b64_tr_b16 v[48:49], v114 offset:24576
  ds_read_b64_tr_b16 v[50:51], v114 offset:25088
  s_waitcnt lgkmcnt(2)
  v_mfma_f32_32x32x16_bf16 v[16:31], v[60:63], v[172:175], v[16:31]
  ds_read_b64_tr_b16 v[52:53], v114 offset:26624
  ds_read_b64_tr_b16 v[54:55], v114 offset:27136
  s_add_u32 m0, s55, 0
  s_add_u32 s40, s84, 32768
  buffer_load_dwordx4 v4, s[12:15], s84 offen lds
  s_add_u32 m0, s55, 8192
  s_nop 0
  buffer_load_dwordx4 v4, s[12:15], s40 offen lds
  s_waitcnt vmcnt(2)
  s_mov_b32 s24, 0
P0_fl11:
  v_cmp_ne_u32 vcc, s54, v125
  s_nop 4
  s_cmp_eq_u64 vcc, 0
  s_cbranch_scc1 P0_fo10
  s_add_u32 s24, s24, 1
  s_cmp_ge_u32 s24, 0x8000
  s_cbranch_scc1 P0_fo10
  s_mov_b32 s41, 4096
  buffer_load_dword v125, v124, s[16:19], s41 offen sc1
  s_waitcnt vmcnt(0)
  s_branch P0_fl11
P0_fo10:
  s_mov_b32 s3, s24
  s_cmp_eq_u32 s34, 0
  s_cbranch_scc0 P0_rz12
  buffer_load_dwordx4 v[72:75], v117, s[16:19], s59 offen sc1
P0_rz12:
  buffer_load_dwordx4 v[118:121], v0, s[16:19], s58 offen sc1
  s_waitcnt lgkmcnt(2)
  v_mfma_f32_32x32x16_bf16 v[16:31], v[48:51], v[176:179], v[16:31]
  ds_read_b64_tr_b16 v[56:57], v114 offset:28672
  ds_read_b64_tr_b16 v[58:59], v114 offset:29184
  s_waitcnt lgkmcnt(2)
  v_mfma_f32_32x32x16_bf16 v[16:31], v[52:55], v[180:183], v[16:31]
  ds_read_b64_tr_b16 v[60:61], v114 offset:30720
  ds_read_b64_tr_b16 v[62:63], v114 offset:31232
  s_waitcnt lgkmcnt(2)
  v_mfma_f32_32x32x16_bf16 v[16:31], v[56:59], v[184:187], v[16:31]
  ds_read_b64_tr_b16 v[48:49], v114 offset:32768
  ds_read_b64_tr_b16 v[50:51], v114 offset:33280
  s_waitcnt lgkmcnt(2)
  v_mfma_f32_32x32x16_bf16 v[16:31], v[60:63], v[188:191], v[16:31]
  ds_read_b64_tr_b16 v[52:53], v114 offset:34816
  ds_read_b64_tr_b16 v[54:55], v114 offset:35328
  s_waitcnt lgkmcnt(2)
  v_mfma_f32_32x32x16_bf16 v[16:31], v[48:51], v[192:195], v[16:31]
  ds_read_b64_tr_b16 v[56:57], v114 offset:36864
  ds_read_b64_tr_b16 v[58:59], v114 offset:37376
  s_waitcnt lgkmcnt(2)
  v_mfma_f32_32x32x16_bf16 v[16:31], v[52:55], v[196:199], v[16:31]
  ds_read_b64_tr_b16 v[60:61], v114 offset:38912
  ds_read_b64_tr_b16 v[62:63], v114 offset:39424
  s_waitcnt lgkmcnt(2)
  v_mfma_f32_32x32x16_bf16 v[16:31], v[56:59], v[200:203], v[16:31]
  ds_read_b64_tr_b16 v[48:49], v114 offset:40960
  ds_read_b64_tr_b16 v[50:51], v114 offset:41472
  s_waitcnt lgkmcnt(2)
  v_mfma_f32_32x32x16_bf16 v[16:31], v[60:63], v[204:207], v[16:31]
  ds_read_b64_tr_b16 v[52:53], v114 offset:43008
  ds_read_b64_tr_b16 v[54:55], v114 offset:43520
  s_waitcnt lgkmcnt(2)
  v_mfma_f32_32x32x16_bf16 v[16:31], v[48:51], v[208:211], v[16:31]
  ds_read_b64_tr_b16 v[56:57], v114 offset:45056
  ds_read_b64_tr_b16 v[58:59], v114 offset:45568
  s_waitcnt lgkmcnt(2)
  v_mfma_f32_32x32x16_bf16 v[16:31], v[52:55], v[212:215], v[16:31]
  ds_read_b64_tr_b16 v[60:61], v114 offset:47104
  ds_read_b64_tr_b16 v[62:63], v114 offset:47616
  s_add_u32 m0, s55, 16384
  s_add_u32 s40, s85, 32768
  buffer_load_dwordx4 v4, s[12:15], s85 offen lds
  s_add_u32 m0, s55, 24576
  s_nop 0
  buffer_load_dwordx4 v4, s[12:15], s40 offen lds
  s_waitcnt lgkmcnt(2)
  v_mfma_f32_32x32x16_bf16 v[16:31], v[56:59], v[216:219], v[16:31]
  ds_read_b64_tr_b16 v[48:49], v114 offset:49152
  ds_read_b64_tr_b16 v[50:51], v114 offset:49664
  s_waitcnt lgkmcnt(2)
  v_mfma_f32_32x32x16_bf16 v[16:31], v[60:63], v[220:223], v[16:31]
  ds_read_b64_tr_b16 v[52:53], v114 offset:51200
  ds_read_b64_tr_b16 v[54:55], v114 offset:51712
  s_waitcnt lgkmcnt(2)
  v_mfma_f32_32x32x16_bf16 v[16:31], v[48:51], v[224:227], v[16:31]
  ds_read_b64_tr_b16 v[56:57], v114 offset:53248
  ds_read_b64_tr_b16 v[58:59], v114 offset:53760
  s_waitcnt lgkmcnt(2)
  v_mfma_f32_32x32x16_bf16 v[16:31], v[52:55], v[228:231], v[16:31]
  ds_read_b64_tr_b16 v[60:61], v114 offset:55296
  ds_read_b64_tr_b16 v[62:63], v114 offset:55808
  s_waitcnt lgkmcnt(2)
  v_mfma_f32_32x32x16_bf16 v[16:31], v[56:59], v[232:235], v[16:31]
  ds_read_b64_tr_b16 v[48:49], v114 offset:57344
  ds_read_b64_tr_b16 v[50:51], v114 offset:57856
  s_waitcnt lgkmcnt(2)
  v_mfma_f32_32x32x16_bf16 v[16:31], v[60:63], v[236:239], v[16:31]
  ds_read_b64_tr_b16 v[52:53], v114 offset:59392
  ds_read_b64_tr_b16 v[54:55], v114 offset:59904
  s_waitcnt vmcnt(2)
  s_mov_b32 s24, 0
P0_rl14:
  s_mov_b32 s44, 0x0c0c0400
  v_perm_b32 v124, v119, v118, s44
  s_mov_b32 s44, 0x04000c0c
  v_perm_b32 v125, v121, v120, s44
  v_or_b32 v124, v124, v125
  v_cmp_ne_u32 vcc, s25, v124
  s_nop 4
  s_cmp_eq_u64 vcc, 0
  s_cbranch_scc1 P0_ro13
  s_add_u32 s24, s24, 1
  s_cmp_ge_u32 s24, 0x8000
  s_cbranch_scc1 P0_ro13
  s_sleep 2
  buffer_load_dwordx4 v[118:121], v0, s[16:19], s58 offen sc1
  s_waitcnt vmcnt(0)
  s_branch P0_rl14
P0_ro13:
  s_mov_b32 s39, s24
  v_add_f32_dpp v118, v118, v118 row_ror:4 row_mask:0xf bank_mask:0xf
  v_add_f32_dpp v119, v119, v119 row_ror:4 row_mask:0xf bank_mask:0xf
  v_add_f32_dpp v120, v120, v120 row_ror:4 row_mask:0xf bank_mask:0xf
  v_add_f32_dpp v121, v121, v121 row_ror:4 row_mask:0xf bank_mask:0xf
  v_add_f32_dpp v118, v118, v118 row_ror:8 row_mask:0xf bank_mask:0xf
  v_add_f32_dpp v119, v119, v119 row_ror:8 row_mask:0xf bank_mask:0xf
  v_add_f32_dpp v120, v120, v120 row_ror:8 row_mask:0xf bank_mask:0xf
  v_add_f32_dpp v121, v121, v121 row_ror:8 row_mask:0xf bank_mask:0xf
  v_mov_b32 v64, v118
  v_mov_b32 v65, v119
  v_mov_b32 v66, v120
  v_mov_b32 v67, v121
  v_permlane16_swap_b32 v118, v64
  v_permlane16_swap_b32 v119, v65
  v_permlane16_swap_b32 v120, v66
  v_permlane16_swap_b32 v121, v67
  v_add_f32 v118, v118, v64
  v_add_f32 v119, v119, v65
  v_add_f32 v120, v120, v66
  v_add_f32 v121, v121, v67
  v_mov_b32 v64, v118
  v_mov_b32 v65, v119
  v_mov_b32 v66, v120
  v_mov_b32 v67, v121
  v_permlane32_swap_b32 v118, v64
  v_permlane32_swap_b32 v119, v65
  v_permlane32_swap_b32 v120, v66
  v_permlane32_swap_b32 v121, v67
  v_add_f32 v118, v118, v64
  v_add_f32 v119, v119, v65
  v_add_f32 v120, v120, v66
  v_add_f32 v121, v121, v67
  v_cvt_pk_bf16_f32 v64, v118, v119
  v_cvt_pk_bf16_f32 v65, v120, v121
  s_mov_b64 exec, 15
  buffer_store_dwordx2 v[64:65], v2, s[16:19], s67 offen sc1
  s_mov_b64 exec, -1
P0_rs15:
  s_cmp_eq_u32 s34, 0
  s_cbranch_scc0 P0_rz16
  s_mov_b32 s24, 0
P0_rz18:
  s_mov_b32 s44, 0x0c0c0400
  v_perm_b32 v124, v73, v72, s44
  s_mov_b32 s44, 0x04000c0c
  v_perm_b32 v125, v75, v74, s44
  v_or_b32 v124, v124, v125
  v_cmp_ne_u32 vcc, s25, v124
  s_nop 4
  s_cmp_eq_u64 vcc, 0
  s_cbranch_scc1 P0_rz17
  s_add_u32 s24, s24, 1
  s_cmp_ge_u32 s24, 0x8000
  s_cbranch_scc1 P0_rz17
  s_sleep 2
  buffer_load_dwordx4 v[72:75], v117, s[16:19], s59 offen sc1
  s_waitcnt vmcnt(0)
  s_branch P0_rz18
P0_rz17:
  v_add_f32_dpp v72, v72, v72 row_ror:4 row_mask:0xf bank_mask:0xf
  v_add_f32_dpp v73, v73, v73 row_ror:4 row_mask:0xf bank_mask:0xf
  v_add_f32_dpp v74, v74, v74 row_ror:4 row_mask:0xf bank_mask:0xf
  v_add_f32_dpp v75, v75, v75 row_ror:4 row_mask:0xf bank_mask:0xf
  v_add_f32_dpp v72, v72, v72 row_ror:8 row_mask:0xf bank_mask:0xf
  v_add_f32_dpp v73, v73, v73 row_ror:8 row_mask:0xf bank_mask:0xf
  v_add_f32_dpp v74, v74, v74 row_ror:8 row_mask:0xf bank_mask:0xf
  v_add_f32_dpp v75, v75, v75 row_ror:8 row_mask:0xf bank_mask:0xf
  v_mov_b32 v68, v72
  v_mov_b32 v69, v73
  v_mov_b32 v70, v74
  v_mov_b32 v71, v75
  v_permlane16_swap_b32 v72, v68
  v_permlane16_swap_b32 v73, v69
  v_permlane16_swap_b32 v74, v70
  v_permlane16_swap_b32 v75, v71
  v_add_f32 v72, v72, v68
  v_add_f32 v73, v73, v69
  v_add_f32 v74, v74, v70
  v_add_f32 v75, v75, v71
  v_mov_b32 v68, v72
  v_mov_b32 v69, v73
  v_mov_b32 v70, v74
  v_mov_b32 v71, v75
  v_permlane32_swap_b32 v72, v68
  v_permlane32_swap_b32 v73, v69
  v_permlane32_swap_b32 v74, v70
  v_permlane32_swap_b32 v75, v71
  v_add_f32 v72, v72, v68
  v_add_f32 v73, v73, v69
  v_add_f32 v74, v74, v70
  v_add_f32 v75, v75, v71
  v_cvt_pk_bf16_f32 v68, v72, v73
  v_cvt_pk_bf16_f32 v69, v74, v75
  v_lshlrev_b32 v124, 5, v1
  s_mov_b64 exec, 3
  buffer_store_dwordx2 v[68:69], v124, s[16:19], s68 offen sc1
  s_mov_b64 exec, -1
P0_rz16:
  s_waitcnt lgkmcnt(2)
  v_mfma_f32_32x32x16_bf16 v[16:31], v[48:51], v[240:243], v[16:31]
  ds_read_b64_tr_b16 v[56:57], v114 offset:61440
  ds_read_b64_tr_b16 v[58:59], v114 offset:61952
  s_waitcnt lgkmcnt(2)
  v_mfma_f32_32x32x16_bf16 v[16:31], v[52:55], v[244:247], v[16:31]
  ds_read_b64_tr_b16 v[60:61], v114 offset:63488
  ds_read_b64_tr_b16 v[62:63], v114 offset:64000
  s_waitcnt lgkmcnt(2)
  v_mfma_f32_32x32x16_bf16 v[16:31], v[56:59], v[248:251], v[16:31]
  s_waitcnt lgkmcnt(0)
  v_mfma_f32_32x32x16_bf16 v[16:31], v[60:63], v[252:255], v[16:31]
  s_add_u32 m0, s55, 32768
  s_add_u32 s40, s86, 32768
  buffer_load_dwordx4 v4, s[12:15], s86 offen lds
  s_add_u32 m0, s55, 40960
  s_nop 0
  buffer_load_dwordx4 v4, s[12:15], s40 offen lds
  s_nop 5
  v_cvt_pk_bf16_f32 v64, v16, v17
  v_cvt_pk_bf16_f32 v65, v18, v19
  v_cvt_pk_bf16_f32 v66, v20, v21
  v_cvt_pk_bf16_f32 v67, v22, v23
  v_cvt_pk_bf16_f32 v68, v24, v25
  v_cvt_pk_bf16_f32 v69, v26, v27
  v_cvt_pk_bf16_f32 v70, v28, v29
  v_cvt_pk_bf16_f32 v71, v30, v31
  v_mfma_f32_32x32x16_bf16 v[72:87], v[104:107], v[64:67], 0
  s_nop 0
  v_mfma_f32_32x32x16_bf16 v[72:87], v[108:111], v[68:71], v[72:87]
  s_nop 11
  v_max3_f32 v64, v72, v73, v74
  v_min3_f32 v65, v72, v73, v74
  v_max3_f32 v66, v75, v76, v77
  v_min3_f32 v67, v75, v76, v77
  v_max3_f32 v68, v80, v81, v82
  v_min3_f32 v69, v80, v81, v82
  v_max3_f32 v70, v83, v84, v85
  v_min3_f32 v71, v83, v84, v85
  v_max3_f32 v64, v64, v78, v79
  v_min3_f32 v65, v65, v78, v79
  v_max3_f32 v68, v68, v86, v87
  v_min3_f32 v69, v69, v86, v87
  v_max_f32 v64, v64, v66
  v_min_f32 v65, v65, v67
  v_max_f32 v68, v68, v70
  v_min_f32 v69, v69, v71
  v_mul_f32 v64, 0xbfb8aa3b, v64
  v_mul_f32 v68, 0xbfb8aa3b, v68
  v_mul_f32 v65, v126, v65
  v_mul_f32 v69, v126, v69
  s_nop 0
  v_permlane32_swap_b32 v64, v65
  v_permlane32_swap_b32 v68, v69
  v_min_f32 v64, v64, v65
  v_min_f32 v68, v68, v69
  v_mov_b32 v65, v64
  v_mov_b32 v69, v68
  s_nop 0
  v_permlane32_swap_b32 v64, v65
  v_permlane32_swap_b32 v68, v69
  v_fmamk_f32 v88, v72, 0x3fb8aa3b, v64
  v_fmamk_f32 v72, v72, 0xbfb8aa3b, v65
  v_fmamk_f32 v89, v73, 0x3fb8aa3b, v64
  v_fmamk_f32 v73, v73, 0xbfb8aa3b, v65
  v_fmamk_f32 v90, v74, 0x3fb8aa3b, v64
  v_fmamk_f32 v74, v74, 0xbfb8aa3b, v65
  v_fmamk_f32 v91, v75, 0x3fb8aa3b, v64
  v_fmamk_f32 v75, v75, 0xbfb8aa3b, v65
  v_fmamk_f32 v92, v76, 0x3fb8aa3b, v64
  v_fmamk_f32 v76, v76, 0xbfb8aa3b, v65
  v_fmamk_f32 v93, v77, 0x3fb8aa3b, v64
  v_fmamk_f32 v77, v77, 0xbfb8aa3b, v65
  v_fmamk_f32 v94, v78, 0x3fb8aa3b, v64
  v_fmamk_f32 v78, v78, 0xbfb8aa3b, v65
  v_fmamk_f32 v95, v79, 0x3fb8aa3b, v64
  v_fmamk_f32 v79, v79, 0xbfb8aa3b, v65
  v_fmamk_f32 v96, v80, 0x3fb8aa3b, v68
  v_fmamk_f32 v80, v80, 0xbfb8aa3b, v69
  v_fmamk_f32 v97, v81, 0x3fb8aa3b, v68
  v_fmamk_f32 v81, v81, 0xbfb8aa3b, v69
  v_fmamk_f32 v98, v82, 0x3fb8aa3b, v68
  v_fmamk_f32 v82, v82, 0xbfb8aa3b, v69
  v_fmamk_f32 v99, v83, 0x3fb8aa3b, v68
  v_fmamk_f32 v83, v83, 0xbfb8aa3b, v69
  v_fmamk_f32 v100, v84, 0x3fb8aa3b, v68
  v_fmamk_f32 v84, v84, 0xbfb8aa3b, v69
  v_fmamk_f32 v101, v85, 0x3fb8aa3b, v68
  v_fmamk_f32 v85, v85, 0xbfb8aa3b, v69
  v_fmamk_f32 v102, v86, 0x3fb8aa3b, v68
  v_fmamk_f32 v86, v86, 0xbfb8aa3b, v69
  v_fmamk_f32 v103, v87, 0x3fb8aa3b, v68
  v_fmamk_f32 v87, v87, 0xbfb8aa3b, v69
  v_exp_f32 v88, v88
  v_exp_f32 v72, v72
  v_exp_f32 v89, v89
  v_exp_f32 v73, v73
  v_exp_f32 v90, v90
  v_exp_f32 v74, v74
  v_exp_f32 v91, v91
  v_exp_f32 v75, v75
  v_exp_f32 v92, v92
  v_exp_f32 v76, v76
  v_exp_f32 v93, v93
  v_exp_f32 v77, v77
  v_exp_f32 v94, v94
  v_exp_f32 v78, v78
  v_exp_f32 v95, v95
  v_exp_f32 v79, v79
  v_exp_f32 v96, v96
  v_exp_f32 v80, v80
  v_exp_f32 v97, v97
  v_exp_f32 v81, v81
  v_exp_f32 v98, v98
  v_exp_f32 v82, v82
  v_exp_f32 v99, v99
  v_exp_f32 v83, v83
  v_exp_f32 v100, v100
  v_exp_f32 v84, v84
  v_exp_f32 v101, v101
  v_exp_f32 v85, v85
  v_exp_f32 v102, v102
  v_exp_f32 v86, v86
  v_exp_f32 v103, v103
  v_exp_f32 v87, v87
  v_cvt_pk_bf16_f32 v16, v88, v89
  v_cvt_pk_bf16_f32 v17, v90, v91
  v_cvt_pk_bf16_f32 v18, v92, v93
  v_cvt_pk_bf16_f32 v19, v94, v95
  v_cvt_pk_bf16_f32 v20, v72, v73
  v_cvt_pk_bf16_f32 v21, v74, v75
  v_cvt_pk_bf16_f32 v22, v76, v77
  v_cvt_pk_bf16_f32 v23, v78, v79
  v_cvt_pk_bf16_f32 v24, v96, v97
  v_cvt_pk_bf16_f32 v25, v98, v99
  v_cvt_pk_bf16_f32 v26, v100, v101
  v_cvt_pk_bf16_f32 v27, v102, v103
  v_cvt_pk_bf16_f32 v28, v80, v81
  v_cvt_pk_bf16_f32 v29, v82, v83
  v_cvt_pk_bf16_f32 v30, v84, v85
  v_cvt_pk_bf16_f32 v31, v86, v87
  s_waitcnt vmcnt(0)
  s_barrier
  buffer_load_dwordx4 v[48:51], v13, s[16:19], s65 offen sc1
  buffer_load_dwordx4 v[52:55], v13, s[16:19], s65 offen offset:1024 sc1
  buffer_load_dwordx4 v[112:115], v3, s[16:19], s66 offen offset:0 sc1
  buffer_load_dwordx4 v[116:119], v3, s[16:19], s66 offen offset:16 sc1
  v_lshrrev_b32 v14, 5, v1
  v_bfe_u32 v15, v1, 2, 2
  v_lshl_add_u32 v14, v14, 2, v15
  v_lshlrev_b32 v5, 8, v14
  v_lshlrev_b32 v15, 2, v15
  v_bfe_u32 v14, v1, 4, 1
  v_lshlrev_b32 v14, 1, v14
  v_bfe_u32 v6, v1, 1, 1
  v_add_u32 v14, v14, v6
  s_and_b32 s41, s34, 3
  s_lshl_b32 s41, s41, 2
  v_add_u32 v14, s41, v14
  v_xor_b32 v14, v14, v15
  v_lshl_add_u32 v5, v14, 4, v5
  v_and_b32 v15, 1, v1
  v_lshl_add_u32 v5, v15, 3, v5
  v_add_u32 v6, 0x10000, v5
  v_add_u32 v7, 0x20000, v5
  ds_read_b64_tr_b16 v[128:129], v5 offset:49152
  ds_read_b64_tr_b16 v[130:131], v5 offset:51200
  ds_read_b64_tr_b16 v[132:133], v5 offset:53248
  ds_read_b64_tr_b16 v[134:135], v5 offset:55296
  ds_read_b64_tr_b16 v[136:137], v5 offset:57344
  ds_read_b64_tr_b16 v[138:139], v5 offset:59392
  ds_read_b64_tr_b16 v[140:141], v5 offset:61440
  ds_read_b64_tr_b16 v[142:143], v5 offset:63488
  ds_read_b64_tr_b16 v[144:145], v6 offset:0
  ds_read_b64_tr_b16 v[146:147], v6 offset:2048
  ds_read_b64_tr_b16 v[148:149], v6 offset:4096
  ds_read_b64_tr_b16 v[150:151], v6 offset:6144
  ds_read_b64_tr_b16 v[152:153], v6 offset:8192
  ds_read_b64_tr_b16 v[154:155], v6 offset:10240
  ds_read_b64_tr_b16 v[156:157], v6 offset:12288
  ds_read_b64_tr_b16 v[158:159], v6 offset:14336
  ds_read_b64_tr_b16 v[160:161], v6 offset:16384
  ds_read_b64_tr_b16 v[162:163], v6 offset:18432
  ds_read_b64_tr_b16 v[164:165], v6 offset:20480
  ds_read_b64_tr_b16 v[166:167], v6 offset:22528
  ds_read_b64_tr_b16 v[168:169], v6 offset:24576
  ds_read_b64_tr_b16 v[170:171], v6 offset:26624
  ds_read_b64_tr_b16 v[172:173], v6 offset:28672
  ds_read_b64_tr_b16 v[174:175], v6 offset:30720
  ds_read_b64_tr_b16 v[176:177], v5 offset:0
  ds_read_b64_tr_b16 v[178:179], v5 offset:2048
  ds_read_b64_tr_b16 v[180:181], v5 offset:4096
  ds_read_b64_tr_b16 v[182:183], v5 offset:6144
  ds_read_b64_tr_b16 v[184:185], v5 offset:8192
  ds_read_b64_tr_b16 v[186:187], v5 offset:10240
  ds_read_b64_tr_b16 v[188:189], v5 offset:12288
  ds_read_b64_tr_b16 v[190:191], v5 offset:14336
  ds_read_b64_tr_b16 v[192:193], v5 offset:16384
  ds_read_b64_tr_b16 v[194:195], v5 offset:18432
  ds_read_b64_tr_b16 v[196:197], v5 offset:20480
  ds_read_b64_tr_b16 v[198:199], v5 offset:22528
  ds_read_b64_tr_b16 v[200:201], v5 offset:24576
  ds_read_b64_tr_b16 v[202:203], v5 offset:26624
  ds_read_b64_tr_b16 v[204:205], v5 offset:28672
  ds_read_b64_tr_b16 v[206:207], v5 offset:30720
  ds_read_b64_tr_b16 v[208:209], v5 offset:32768
  ds_read_b64_tr_b16 v[210:211], v5 offset:34816
  ds_read_b64_tr_b16 v[212:213], v5 offset:36864
  ds_read_b64_tr_b16 v[214:215], v5 offset:38912
  ds_read_b64_tr_b16 v[216:217], v5 offset:40960
  ds_read_b64_tr_b16 v[218:219], v5 offset:43008
  ds_read_b64_tr_b16 v[220:221], v5 offset:45056
  ds_read_b64_tr_b16 v[222:223], v5 offset:47104
  s_waitcnt vmcnt(0)
  s_mov_b32 s24, 0
P0_al20:
  v_max3_u32 v66, v48, v49, v50
  v_max3_u32 v66, v66, v51, v52
  v_max3_u32 v66, v66, v53, v54
  v_max3_u32 v66, v66, v55, v112
  v_max3_u32 v66, v66, v113, v114
  v_max3_u32 v66, v66, v115, v116
  v_max3_u32 v66, v66, v117, v118
  v_max_u32 v66, v66, v119
  v_cmp_eq_u32 vcc, -1, v66
  s_nop 4
  s_cmp_eq_u64 vcc, 0
  s_cbranch_scc1 P0_ao19
  s_add_u32 s24, s24, 1
  s_cmp_ge_u32 s24, 0x8000
  s_cbranch_scc1 P0_ao19
  s_sleep 4
  buffer_load_dwordx4 v[48:51], v13, s[16:19], s65 offen sc1
  buffer_load_dwordx4 v[52:55], v13, s[16:19], s65 offen offset:1024 sc1
  buffer_load_dwordx4 v[112:115], v3, s[16:19], s66 offen offset:0 sc1
  buffer_load_dwordx4 v[116:119], v3, s[16:19], s66 offen offset:16 sc1
  s_waitcnt vmcnt(0)
  s_branch P0_al20
P0_ao19:
  s_mov_b32 s26, s24
  v_mov_b32 v56, v48
  v_mov_b32 v57, v49
  v_mov_b32 v58, v50
  v_mov_b32 v59, v51
  v_mov_b32 v60, v52
  v_mov_b32 v61, v53
  v_mov_b32 v62, v54
  v_mov_b32 v63, v55
  s_mov_b64 exec, s[62:63]
  v_mov_b32 v56, v112
  v_mov_b32 v57, v113
  v_mov_b32 v58, v114
  v_mov_b32 v59, v115
  v_mov_b32 v60, v116
  v_mov_b32 v61, v117
  v_mov_b32 v62, v118
  v_mov_b32 v63, v119
  s_mov_b64 exec, s[60:61]
  v_mov_b32 v48, v112
  v_mov_b32 v49, v113
  v_mov_b32 v50, v114
  v_mov_b32 v51, v115
  v_mov_b32 v52, v116
  v_mov_b32 v53, v117
  v_mov_b32 v54, v118
  v_mov_b32 v55, v119
  s_mov_b32 exec_lo, 0x11000000
  s_mov_b32 exec_hi, 0x11000000
  v_mov_b32 v48, 0x3f803f80
  v_mov_b32 v49, 0x3f803f80
  v_mov_b32 v50, 0x3f803f80
  v_mov_b32 v51, 0x3f803f80
  v_mov_b32 v52, 0x3f803f80
  v_mov_b32 v53, 0x3f803f80
  v_mov_b32 v54, 0x3f803f80
  v_mov_b32 v55, 0x3f803f80
  s_mov_b32 exec_lo, 0x00001100
  s_mov_b32 exec_hi, 0x00001100
  v_mov_b32 v56, 0x3f803f80
  v_mov_b32 v57, 0x3f803f80
  v_mov_b32 v58, 0x3f803f80
  v_mov_b32 v59, 0x3f803f80
  v_mov_b32 v60, 0x3f803f80
  v_mov_b32 v61, 0x3f803f80
  v_mov_b32 v62, 0x3f803f80
  v_mov_b32 v63, 0x3f803f80
  s_mov_b64 exec, -1
  v_mfma_f32_32x32x16_bf16 v[32:47], v[48:51], v[16:19], 0
  v_mfma_f32_32x32x16_bf16 v[72:87], v[52:55], v[20:23], 0
  v_mfma_f32_32x32x16_bf16 v[240:255], v[56:59], v[24:27], 0
  v_mfma_f32_32x32x16_bf16 v[224:239], v[60:63], v[28:31], 0
  s_nop 9
  v_rcp_f32 v64, v84
  s_nop 0
  v_rcp_f32 v65, v228
  v_mul_f32 v64, v64, v44
  v_mul_f32 v65, v65, v244
  v_fmac_f32 v40, v64, v80
  v_fmac_f32 v240, v65, v224
  v_fmac_f32 v40, v127, v44
  v_fmac_f32 v240, v127, v244
  v_rcp_f32 v66, v40
  v_rcp_f32 v67, v240
  v_fmac_f32 v32, v64, v72
  v_fmac_f32 v248, v65, v232
  v_fmac_f32 v33, v64, v73
  v_fmac_f32 v249, v65, v233
  v_fmac_f32 v34, v64, v74
  v_fmac_f32 v250, v65, v234
  v_fmac_f32 v35, v64, v75
  v_fmac_f32 v251, v65, v235
  v_fmac_f32 v36, v64, v76
  v_fmac_f32 v252, v65, v236
  v_fmac_f32 v37, v64, v77
  v_fmac_f32 v253, v65, v237
  v_fmac_f32 v38, v64, v78
  v_fmac_f32 v254, v65, v238
  v_fmac_f32 v39, v64, v79
  v_fmac_f32 v255, v65, v239
  v_mul_f32 v32, v32, v66
  v_mul_f32 v248, v248, v67
  v_mul_f32 v33, v33, v66
  v_mul_f32 v249, v249, v67
  v_mul_f32 v34, v34, v66
  v_mul_f32 v250, v250, v67
  v_mul_f32 v35, v35, v66
  v_mul_f32 v251, v251, v67
  v_mul_f32 v36, v36, v66
  v_mul_f32 v252, v252, v67
  v_mul_f32 v37, v37, v66
  v_mul_f32 v253, v253, v67
  v_mul_f32 v38, v38, v66
  v_mul_f32 v254, v254, v67
  v_mul_f32 v39, v39, v66
  v_mul_f32 v255, v255, v67
  v_cvt_pk_bf16_f32 v88, v32, v33
  v_cvt_pk_bf16_f32 v89, v34, v35
  v_cvt_pk_bf16_f32 v90, v36, v37
  v_cvt_pk_bf16_f32 v91, v38, v39
  v_cvt_pk_bf16_f32 v92, v248, v249
  v_cvt_pk_bf16_f32 v93, v250, v251
  v_cvt_pk_bf16_f32 v94, v252, v253
  v_cvt_pk_bf16_f32 v95, v254, v255
  v_mov_b32 v64, s96
  s_mov_b32 s44, 0xfffefffe
  v_and_or_b32 v88, v88, s44, v64
  v_and_or_b32 v89, v89, s44, v64
  v_and_or_b32 v90, v90, s44, v64
  v_and_or_b32 v91, v91, s44, v64
  v_and_or_b32 v92, v92, s44, v64
  v_and_or_b32 v93, v93, s44, v64
  v_and_or_b32 v94, v94, s44, v64
  v_and_or_b32 v95, v95, s44, v64
  buffer_store_dwordx4 v[88:91], v13, s[16:19], s64 offen sc1
  buffer_store_dwordx4 v[92:95], v13, s[16:19], s64 offen offset:1024 sc1
  s_waitcnt lgkmcnt(0)
  s_barrier
  s_add_u32 m0, s55, 49152
  s_add_u32 s40, s87, 32768
  buffer_load_dwordx4 v4, s[12:15], s87 offen lds
  s_add_u32 m0, s55, 57344
  s_nop 0
  buffer_load_dwordx4 v4, s[12:15], s40 offen lds
  s_add_u32 m0, s55, 65536
  s_add_u32 s40, s88, 32768
  buffer_load_dwordx4 v4, s[12:15], s88 offen lds
  s_add_u32 m0, s55, 73728
  s_nop 0
  buffer_load_dwordx4 v4, s[12:15], s40 offen lds
  v_and_b32 v112, 31, v1
  s_lshl_b32 s42, s36, 5
  v_add_u32 v112, s42, v112
  v_and_b32 v113, 15, v112
  s_lshl_b32 s42, s35, 2
  v_xor_b32 v113, s42, v113
  v_lshlrev_b32 v112, 8, v112
  v_lshrrev_b32 v114, 5, v1
  v_lshl_add_u32 v112, v114, 3, v112
  v_xor_b32 v96, 0, v113
  v_lshl_add_u32 v96, v96, 4, v112
  v_xor_b32 v97, 1, v113
  v_lshl_add_u32 v97, v97, 4, v112
  v_xor_b32 v98, 2, v113
  v_lshl_add_u32 v98, v98, 4, v112
  v_xor_b32 v99, 3, v113
  v_lshl_add_u32 v99, v99, 4, v112
  v_lshrrev_b32 v112, 4, v1
  s_lshl_b32 s42, s34, 3
  v_add_u32 v112, s42, v112
  v_and_b32 v113, 15, v1
  v_add_u32 v114, 0, v112
  v_and_b32 v100, 15, v114
  v_xor_b32 v100, v100, v113
  v_lshlrev_b32 v100, 4, v100
  v_lshl_add_u32 v100, v114, 8, v100
  v_add_u32 v114, 4, v112
  v_and_b32 v101, 15, v114
  v_xor_b32 v101, v101, v113
  v_lshlrev_b32 v101, 4, v101
  v_lshl_add_u32 v101, v114, 8, v101
  v_lshlrev_b32 v102, 11, v112
  v_lshl_add_u32 v102, v113, 4, v102
  s_lshl_b32 s41, s36, 15
  s_add_u32 s41, s41, 98304
  v_add_u32 v103, s41, v13
  s_waitcnt vmcnt(4)
  s_mov_b32 s24, 0
  v_add_u32 v14, s55, v13
  v_add_u32 v14, 98304, v14
P0_ol22:
  s_add_u32 m0, s55, 98304
  s_nop 0
  buffer_load_dwordx4 v13, s[16:19], s73 offen sc1 lds
  s_add_u32 m0, s55, 106496
  s_nop 0
  buffer_load_dwordx4 v13, s[16:19], s74 offen sc1 lds
  s_add_u32 m0, s55, 114688
  s_nop 0
  buffer_load_dwordx4 v13, s[16:19], s75 offen sc1 lds
  s_add_u32 m0, s55, 122880
  s_nop 0
  buffer_load_dwordx4 v13, s[16:19], s76 offen sc1 lds
  s_add_u32 m0, s55, 131072
  s_nop 0
  buffer_load_dwordx4 v13, s[16:19], s77 offen sc1 lds
  s_add_u32 m0, s55, 139264
  s_nop 0
  buffer_load_dwordx4 v13, s[16:19], s78 offen sc1 lds
  s_add_u32 m0, s55, 147456
  s_nop 0
  buffer_load_dwordx4 v13, s[16:19], s79 offen sc1 lds
  s_add_u32 m0, s55, 155648
  s_nop 0
  buffer_load_dwordx4 v13, s[16:19], s80 offen sc1 lds
  s_waitcnt vmcnt(0)
  ds_read_b128 v[32:35], v14 offset:0
  ds_read_b128 v[36:39], v14 offset:8192
  ds_read_b128 v[40:43], v14 offset:16384
  ds_read_b128 v[44:47], v14 offset:24576
  ds_read_b128 v[72:75], v14 offset:32768
  ds_read_b128 v[76:79], v14 offset:40960
  ds_read_b128 v[80:83], v14 offset:49152
  ds_read_b128 v[84:87], v14 offset:57344
  s_waitcnt lgkmcnt(0)
  v_mov_b32 v64, s96
  v_xor_b32 v15, v32, v64
  v_xor_b32 v65, v33, v64
  v_bitop3_b32 v15, v34, v64, v15 bitop3:0xbe
  v_bitop3_b32 v65, v35, v64, v65 bitop3:0xbe
  v_bitop3_b32 v15, v36, v64, v15 bitop3:0xbe
  v_bitop3_b32 v65, v37, v64, v65 bitop3:0xbe
  v_bitop3_b32 v15, v38, v64, v15 bitop3:0xbe
  v_bitop3_b32 v65, v39, v64, v65 bitop3:0xbe
  v_bitop3_b32 v15, v40, v64, v15 bitop3:0xbe
  v_bitop3_b32 v65, v41, v64, v65 bitop3:0xbe
  v_bitop3_b32 v15, v42, v64, v15 bitop3:0xbe
  v_bitop3_b32 v65, v43, v64, v65 bitop3:0xbe
  v_bitop3_b32 v15, v44, v64, v15 bitop3:0xbe
  v_bitop3_b32 v65, v45, v64, v65 bitop3:0xbe
  v_bitop3_b32 v15, v46, v64, v15 bitop3:0xbe
  v_bitop3_b32 v65, v47, v64, v65 bitop3:0xbe
  v_bitop3_b32 v15, v72, v64, v15 bitop3:0xbe
  v_bitop3_b32 v65, v73, v64, v65 bitop3:0xbe
  v_bitop3_b32 v15, v74, v64, v15 bitop3:0xbe
  v_bitop3_b32 v65, v75, v64, v65 bitop3:0xbe
  v_bitop3_b32 v15, v76, v64, v15 bitop3:0xbe
  v_bitop3_b32 v65, v77, v64, v65 bitop3:0xbe
  v_bitop3_b32 v15, v78, v64, v15 bitop3:0xbe
  v_bitop3_b32 v65, v79, v64, v65 bitop3:0xbe
  v_bitop3_b32 v15, v80, v64, v15 bitop3:0xbe
  v_bitop3_b32 v65, v81, v64, v65 bitop3:0xbe
  v_bitop3_b32 v15, v82, v64, v15 bitop3:0xbe
  v_bitop3_b32 v65, v83, v64, v65 bitop3:0xbe
  v_bitop3_b32 v15, v84, v64, v15 bitop3:0xbe
  v_bitop3_b32 v65, v85, v64, v65 bitop3:0xbe
  v_bitop3_b32 v15, v86, v64, v15 bitop3:0xbe
  v_bitop3_b32 v65, v87, v64, v65 bitop3:0xbe
  v_or_b32 v15, v15, v65
  v_and_b32 v15, 0x00010001, v15
  v_cmp_ne_u32 vcc, 0, v15
  s_nop 4
  s_cmp_eq_u64 vcc, 0
  s_cbranch_scc1 P0_oo21
  s_sleep 2
  s_add_u32 s24, s24, 1
  s_cmp_lt_u32 s24, 0x8000
  s_cbranch_scc1 P0_ol22
P0_oo21:
  s_mov_b32 s27, s24
  s_barrier
  ds_read_b128 v[48:51], v103 offset:0
  ds_read_b128 v[52:55], v103 offset:1024
  ds_read_b128 v[56:59], v103 offset:2048
  ds_read_b128 v[60:63], v103 offset:3072
  ds_read_b128 v[64:67], v103 offset:4096
  ds_read_b128 v[68:71], v103 offset:5120
  ds_read_b128 v[72:75], v103 offset:6144
  ds_read_b128 v[76:79], v103 offset:7168
  s_waitcnt lgkmcnt(7)
  v_mfma_f32_32x32x16_bf16 v[16:31], v[128:131], v[48:51], 0
  ds_read_b64_tr_b16 v[224:225], v5 offset:49152
  ds_read_b64_tr_b16 v[226:227], v5 offset:51200
  ds_read_b64_tr_b16 v[228:229], v5 offset:53248
  s_waitcnt lgkmcnt(9)
  v_mfma_f32_32x32x16_bf16 v[16:31], v[132:135], v[52:55], v[16:31]
  ds_read_b64_tr_b16 v[230:231], v5 offset:55296
  ds_read_b64_tr_b16 v[232:233], v5 offset:57344
  ds_read_b64_tr_b16 v[234:235], v5 offset:59392
  s_waitcnt lgkmcnt(11)
  v_mfma_f32_32x32x16_bf16 v[16:31], v[136:139], v[56:59], v[16:31]
  ds_read_b64_tr_b16 v[236:237], v5 offset:61440
  ds_read_b64_tr_b16 v[238:239], v5 offset:63488
  ds_read_b64_tr_b16 v[240:241], v6 offset:0
  s_waitcnt lgkmcnt(13)
  v_mfma_f32_32x32x16_bf16 v[16:31], v[140:143], v[60:63], v[16:31]
  ds_read_b64_tr_b16 v[242:243], v6 offset:2048
  ds_read_b64_tr_b16 v[244:245], v6 offset:4096
  ds_read_b64_tr_b16 v[246:247], v6 offset:6144
  ds_read_b128 v[48:51], v103 offset:8192
  ds_read_b128 v[52:55], v103 offset:9216
  ds_read_b128 v[56:59], v103 offset:10240
  ds_read_b128 v[60:63], v103 offset:11264
  s_waitcnt lgkmcnt(15)
  v_mfma_f32_32x32x16_bf16 v[16:31], v[144:147], v[64:67], v[16:31]
  ds_read_b64_tr_b16 v[248:249], v6 offset:8192
  ds_read_b64_tr_b16 v[250:251], v6 offset:10240
  ds_read_b64_tr_b16 v[252:253], v6 offset:12288
  s_waitcnt lgkmcnt(15)
  v_mfma_f32_32x32x16_bf16 v[16:31], v[148:151], v[68:71], v[16:31]
  ds_read_b64_tr_b16 v[254:255], v6 offset:14336
  s_waitcnt lgkmcnt(15)
  v_mfma_f32_32x32x16_bf16 v[16:31], v[152:155], v[72:75], v[16:31]
  s_waitcnt lgkmcnt(15)
  v_mfma_f32_32x32x16_bf16 v[16:31], v[156:159], v[76:79], v[16:31]
  ds_read_b128 v[64:67], v103 offset:12288
  ds_read_b128 v[68:71], v103 offset:13312
  ds_read_b128 v[72:75], v103 offset:14336
  ds_read_b128 v[76:79], v103 offset:15360
  s_waitcnt lgkmcnt(11)
  v_mfma_f32_32x32x16_bf16 v[16:31], v[160:163], v[48:51], v[16:31]
  s_waitcnt lgkmcnt(10)
  v_mfma_f32_32x32x16_bf16 v[16:31], v[164:167], v[52:55], v[16:31]
  s_waitcnt lgkmcnt(9)
  v_mfma_f32_32x32x16_bf16 v[16:31], v[168:171], v[56:59], v[16:31]
  s_waitcnt lgkmcnt(8)
  v_mfma_f32_32x32x16_bf16 v[16:31], v[172:175], v[60:63], v[16:31]
  ds_read_b128 v[48:51], v103 offset:16384
  ds_read_b128 v[52:55], v103 offset:17408
  ds_read_b128 v[56:59], v103 offset:18432
  ds_read_b128 v[60:63], v103 offset:19456
  s_waitcnt lgkmcnt(7)
  v_mfma_f32_32x32x16_bf16 v[16:31], v[176:179], v[64:67], v[16:31]
  s_waitcnt lgkmcnt(6)
  v_mfma_f32_32x32x16_bf16 v[16:31], v[180:183], v[68:71], v[16:31]
  s_waitcnt lgkmcnt(5)
  v_mfma_f32_32x32x16_bf16 v[16:31], v[184:187], v[72:75], v[16:31]
  s_waitcnt lgkmcnt(4)
  v_mfma_f32_32x32x16_bf16 v[16:31], v[188:191], v[76:79], v[16:31]
  ds_read_b128 v[64:67], v103 offset:20480
  ds_read_b128 v[68:71], v103 offset:21504
  ds_read_b128 v[72:75], v103 offset:22528
  ds_read_b128 v[76:79], v103 offset:23552
  s_waitcnt lgkmcnt(7)
  v_mfma_f32_32x32x16_bf16 v[16:31], v[192:195], v[48:51], v[16:31]
  s_waitcnt lgkmcnt(6)
  v_mfma_f32_32x32x16_bf16 v[16:31], v[196:199], v[52:55], v[16:31]
  s_waitcnt lgkmcnt(5)
  v_mfma_f32_32x32x16_bf16 v[16:31], v[200:203], v[56:59], v[16:31]
  s_waitcnt lgkmcnt(4)
  v_mfma_f32_32x32x16_bf16 v[16:31], v[204:207], v[60:63], v[16:31]
  ds_read_b128 v[48:51], v103 offset:24576
  ds_read_b128 v[52:55], v103 offset:25600
  ds_read_b128 v[56:59], v103 offset:26624
  ds_read_b128 v[60:63], v103 offset:27648
  s_waitcnt lgkmcnt(7)
  v_mfma_f32_32x32x16_bf16 v[16:31], v[208:211], v[64:67], v[16:31]
  s_waitcnt lgkmcnt(6)
  v_mfma_f32_32x32x16_bf16 v[16:31], v[212:215], v[68:71], v[16:31]
  s_waitcnt lgkmcnt(5)
  v_mfma_f32_32x32x16_bf16 v[16:31], v[216:219], v[72:75], v[16:31]
  s_waitcnt lgkmcnt(4)
  v_mfma_f32_32x32x16_bf16 v[16:31], v[220:223], v[76:79], v[16:31]
  ds_read_b128 v[64:67], v103 offset:28672
  ds_read_b128 v[68:71], v103 offset:29696
  ds_read_b128 v[72:75], v103 offset:30720
  ds_read_b128 v[76:79], v103 offset:31744
  s_waitcnt lgkmcnt(7)
  v_mfma_f32_32x32x16_bf16 v[16:31], v[224:227], v[48:51], v[16:31]
  s_waitcnt lgkmcnt(6)
  v_mfma_f32_32x32x16_bf16 v[16:31], v[228:231], v[52:55], v[16:31]
  s_waitcnt lgkmcnt(5)
  v_mfma_f32_32x32x16_bf16 v[16:31], v[232:235], v[56:59], v[16:31]
  s_waitcnt lgkmcnt(4)
  v_mfma_f32_32x32x16_bf16 v[16:31], v[236:239], v[60:63], v[16:31]
  s_waitcnt lgkmcnt(3)
  v_mfma_f32_32x32x16_bf16 v[16:31], v[240:243], v[64:67], v[16:31]
  s_waitcnt lgkmcnt(2)
  v_mfma_f32_32x32x16_bf16 v[16:31], v[244:247], v[68:71], v[16:31]
  s_waitcnt lgkmcnt(1)
  v_mfma_f32_32x32x16_bf16 v[16:31], v[248:251], v[72:75], v[16:31]
  s_waitcnt lgkmcnt(0)
  v_mfma_f32_32x32x16_bf16 v[16:31], v[252:255], v[76:79], v[16:31]
  s_nop 11
  v_cvt_pk_bf16_f32 v88, v16, v17
  v_cvt_pk_bf16_f32 v89, v18, v19
  v_cvt_pk_bf16_f32 v90, v20, v21
  v_cvt_pk_bf16_f32 v91, v22, v23
  v_cvt_pk_bf16_f32 v92, v24, v25
  v_cvt_pk_bf16_f32 v93, v26, v27
  v_cvt_pk_bf16_f32 v94, v28, v29
  v_cvt_pk_bf16_f32 v95, v30, v31
  ds_write_b64 v96, v[88:89]
  ds_write_b64 v97, v[90:91]
  ds_write_b64 v98, v[92:93]
  ds_write_b64 v99, v[94:95]
  s_waitcnt lgkmcnt(0)
  s_barrier
  ds_read_b128 v[88:91], v100
  ds_read_b128 v[92:95], v101
  s_add_u32 s40, s72, 8192
  s_waitcnt lgkmcnt(1)
  buffer_store_dwordx4 v[88:91], v102, s[20:23], s72 offen nt
  s_waitcnt lgkmcnt(0)
  buffer_store_dwordx4 v[92:95], v102, s[20:23], s40 offen nt
  s_add_u32 s41, s32, s33
  s_add_u32 s41, s41, s34
  s_cmp_eq_u32 s41, 0
  s_cbranch_scc0 P0_nu23
  v_mov_b32 v14, 0
  v_mov_b32 v15, s54
  s_mov_b64 exec, 1
  buffer_store_dword v15, v14, s[16:19], 0 offen offset:0 sc1
  s_mov_b64 exec, -1
P0_nu23:
  s_endpgm
L_exit:
  s_endpgm
.p2align 8
L_progB:
  s_load_dwordx4 s[44:47], s[0:1], 32
  s_load_dwordx2 s[54:55], s[0:1], 48
  s_load_dwordx2 s[52:53], s[0:1], 16
  s_load_dwordx2 s[56:57], s[0:1], 56
  s_load_dwordx2 s[62:63], s[0:1], 72
  v_and_b32 v1, 63, v0
  v_lshrrev_b32 v14, 6, v0
  s_nop 0
  v_readfirstlane_b32 s34, v14
  s_lshr_b32 s40, s2, 3
  s_and_b32 s32, s2, 1
  s_lshl_b32 s32, s32, 3
  s_and_b32 s41, s40, 7
  s_add_u32 s32, s32, s41
  s_bfe_u32 s33, s2, 0x10001
  s_lshl_b32 s33, s33, 2
  s_lshr_b32 s41, s40, 3
  s_add_u32 s33, s33, s41
  s_and_b32 s35, s34, 3
  s_lshr_b32 s36, s34, 2
  s_and_b32 s40, s34, 1
  s_lshl_b32 s40, s40, 2
  v_lshrrev_b32 v14, 4, v1
  v_add_u32 v14, s40, v14
  v_and_b32 v15, 7, v1
  v_xor_b32 v14, v14, v15
  v_lshlrev_b32 v14, 4, v14
  v_lshrrev_b32 v15, 3, v1
  v_lshl_add_u32 v2, v15, 10, v14
  v_bfe_u32 v14, v1, 4, 1
  v_lshlrev_b32 v14, 2, v14
  v_and_b32 v3, 7, v1
  v_xor_b32 v14, v14, v3
  v_lshlrev_b32 v14, 4, v14
  v_mul_u32_u24 v3, 3072, v15
  v_add_u32 v3, v3, v14
  s_lshl_b32 s37, s32, 17
  s_lshl_b32 s40, s34, 13
  s_add_u32 s37, s37, s40
  s_mul_i32 s38, s34, 24576
  s_lshl_b32 s40, s33, 7
  s_add_u32 s38, s38, s40
  v_lshlrev_b32 v13, 4, v1
  s_waitcnt lgkmcnt(0)
  s_add_u32 s62, s62, 0xf000000
  s_addc_u32 s63, s63, 0
  s_mov_b32 s4, s44
  s_mov_b32 s5, s45
  s_mov_b32 s6, 0x200000
  s_mov_b32 s7, 0x20000
  s_mov_b32 s8, s46
  s_mov_b32 s9, s47
  s_mov_b32 s10, 0x180000
  s_mov_b32 s11, 0x20000
  s_mov_b32 s16, s62
  s_mov_b32 s17, s63
  s_mov_b32 s18, 0x1000000
  s_mov_b32 s19, 0x20000
  s_mov_b32 s28, s52
  s_mov_b32 s29, s53
  s_mov_b32 s30, 0x4000
  s_mov_b32 s31, 0x20000
  s_mov_b32 s12, s54
  s_mov_b32 s13, s55
  s_mov_b32 s14, 0x80000
  s_mov_b32 s15, 0x20000
  s_mov_b32 s20, s56
  s_mov_b32 s21, s57
  s_mov_b32 s22, 0x400000
  s_mov_b32 s23, 0x20000
  s_lshl_b32 s55, s34, 10
  s_and_b32 s100, s33, 3
  s_lshl_b32 s100, s100, 1
  s_add_u32 s100, s100, s32
  s_and_b32 s100, s100, 7
  s_cmp_ge_u32 s34, 2
  s_cbranch_scc1 P1_nn1
  v_mov_b32 v14, 0
  buffer_load_dword v16, v14, s[16:19], 0 offen offset:128 sc1
P1_nn1:
  s_add_u32 s101, s100, 0
  s_and_b32 s101, s101, 7
  s_mul_i32 s101, s101, 128
  s_add_u32 s40, s37, s101
  s_add_u32 m0, s55, 0
  s_nop 0
  buffer_load_dwordx4 v2, s[4:7], s40 offen lds
  s_add_u32 s40, s40, 65536
  s_add_u32 m0, s55, 8192
  s_nop 0
  buffer_load_dwordx4 v2, s[4:7], s40 offen lds
  s_add_u32 s101, s100, 0
  s_and_b32 s101, s101, 7
  s_mul_i32 s101, s101, 196608
  s_add_u32 s40, s38, s101
  s_add_u32 s40, s40, 1024
  s_add_u32 m0, s55, 16384
  s_nop 0
  buffer_load_dwordx4 v3, s[8:11], s40 offen lds
  s_add_u32 s40, s40, 1024
  s_add_u32 m0, s55, 24576
  s_nop 0
  buffer_load_dwordx4 v3, s[8:11], s40 offen lds
  s_barrier
  s_lshl_b32 s40, s33, 4
  s_add_u32 s40, s40, 128
  s_mul_i32 s51, s40, 9216
  s_add_u32 s51, s51, 1048576
  s_mul_i32 s57, s32, 9216
  s_add_u32 s57, s57, s51
  s_lshl_b32 s52, s32, 17
  s_add_u32 s52, s52, 10485760
  s_lshl_b32 s53, s33, 13
  s_add_u32 s53, s53, 4259840
  s_mov_b32 s46, 0x0000ffff
  s_mov_b32 s47, 0x0000ffff
  s_mov_b32 s48, 0xffff0000
  s_mov_b32 s49, 0xffff0000
  s_mov_b32 s60, 0x00110000
  s_mov_b32 s61, 0x00110000
  s_mov_b32 s62, 0x00000011
  s_mov_b32 s63, 0x00000011
  v_lshrrev_b32 v15, 4, v1
  v_lshlrev_b32 v14, 2, v15
  v_and_b32 v4, 15, v1
  v_xor_b32 v14, v14, v4
  v_lshlrev_b32 v14, 4, v14
  v_lshl_add_u32 v4, v15, 10, v14
  s_and_b32 s40, s33, 3
  s_lshl_b32 s40, s40, 8
  s_lshl_b32 s56, s34, 12
  s_add_u32 s56, s56, s40
  v_and_b32 v14, 31, v1
  s_lshl_b32 s40, s35, 5
  v_add_u32 v15, s40, v14
  v_lshlrev_b32 v10, 6, v15
  v_lshlrev_b32 v15, 7, v15
  v_bfe_u32 v14, v1, 1, 3
  v_lshrrev_b32 v5, 5, v1
  v_xor_b32 v5, v5, v14
  v_lshl_add_u32 v10, v5, 3, v10
  v_lshl_add_u32 v5, v5, 4, v15
  v_xor_b32 v6, 32, v5
  v_xor_b32 v7, 64, v5
  v_xor_b32 v8, 96, v5
  v_lshrrev_b32 v14, 5, v1
  v_lshlrev_b32 v14, 3, v14
  v_bfe_u32 v15, v1, 2, 2
  v_add_u32 v14, v14, v15
  v_lshlrev_b32 v9, 7, v14
  v_bfe_u32 v14, v1, 4, 1
  v_lshlrev_b32 v14, 1, v14
  v_bfe_u32 v15, v1, 1, 1
  v_add_u32 v14, v14, v15
  s_lshl_b32 s40, s36, 2
  v_add_u32 v14, s40, v14
  v_bfe_u32 v15, v1, 3, 1
  v_lshlrev_b32 v15, 2, v15
  v_xor_b32 v14, v14, v15
  v_lshl_add_u32 v9, v14, 4, v9
  v_and_b32 v15, 1, v1
  v_lshl_add_u32 v9, v15, 3, v9
  v_lshrrev_b32 v14, 5, v1
  v_bfe_u32 v15, v1, 2, 2
  v_lshl_add_u32 v15, v14, 2, v15
  v_lshlrev_b32 v11, 6, v15
  v_lshlrev_b32 v14, 1, v14
  v_bfe_u32 v15, v1, 3, 1
  v_add_u32 v14, v14, v15
  v_bfe_u32 v15, v1, 4, 1
  v_lshlrev_b32 v15, 2, v15
  v_xor_b32 v14, v14, v15
  v_and_b32 v15, 3, v1
  v_xor_b32 v14, v14, v15
  v_lshl_add_u32 v11, v14, 3, v11
  v_xor_b32 v12, 32, v11
  v_add_u32 v12, 512, v12
  v_mov_b32 v126, 0x3fb8aa3b
  v_mov_b32 v127, 0x358637bd
  s_lshl_b32 s64, s35, 15
  s_lshl_b32 s42, s33, 12
  s_add_u32 s64, s64, s42
  s_lshl_b32 s42, s36, 11
  s_add_u32 s64, s64, s42
  s_add_u32 s64, s64, s52
  s_lshl_b32 s65, s36, 10
  s_add_u32 s65, s65, s53
  s_lshl_b32 s66, s36, 6
  s_add_u32 s66, s66, s53
  s_add_u32 s66, s66, 4096
  s_lshr_b32 s58, s32, 3
  s_lshl_b32 s58, s58, 11
  s_and_b32 s42, s32, 7
  s_lshl_b32 s42, s42, 2
  s_add_u32 s42, s42, s35
  s_lshl_b32 s42, s42, 5
  s_add_u32 s58, s58, s42
  s_lshl_b32 s59, s32, 4
  s_lshr_b32 s67, s32, 3
  s_lshl_b32 s67, s67, 10
  s_add_u32 s67, s67, s42
  s_lshr_b32 s68, s32, 2
  s_lshl_b32 s68, s68, 5
  s_and_b32 s42, s32, 1
  s_lshl_b32 s42, s42, 4
  s_add_u32 s68, s68, s42
  s_and_b32 s42, s32, 2
  s_lshl_b32 s42, s42, 2
  s_add_u32 s68, s68, s42
  s_add_u32 s58, s58, s51
  s_add_u32 s59, s59, s51
  s_add_u32 s59, s59, 8192
  s_add_u32 s67, s67, s53
  s_add_u32 s68, s68, s53
  s_add_u32 s68, s68, 4096
  s_and_b32 s42, s34, 1
  s_lshl_b32 s71, s42, 13
  s_add_u32 s71, s71, 32768
  s_lshl_b32 s70, s42, 13
  s_lshl_b32 s43, s42, 11
  s_lshl_b32 s42, s42, 7
  s_add_u32 s42, s42, 8192
  s_bitcmp1_b32 s34, 1
  s_cselect_b32 s69, s42, s43
  s_add_u32 s69, s69, s57
  s_lshr_b32 s42, s33, 2
  s_lshl_b32 s42, s42, 16
  s_add_u32 s42, s42, s52
  s_lshl_b32 s43, s35, 10
  s_add_u32 s42, s42, s43
  s_add_u32 s43, s36, s32
  s_add_u32 s73, s43, 0
  s_and_b32 s73, s73, 7
  s_lshl_b32 s73, s73, 12
  s_add_u32 s73, s73, s42
  s_add_u32 s74, s43, 2
  s_and_b32 s74, s74, 7
  s_lshl_b32 s74, s74, 12
  s_add_u32 s74, s74, s42
  s_add_u32 s75, s43, 4
  s_and_b32 s75, s75, 7
  s_lshl_b32 s75, s75, 12
  s_add_u32 s75, s75, s42
  s_add_u32 s76, s43, 6
  s_and_b32 s76, s76, 7
  s_lshl_b32 s76, s76, 12
  s_add_u32 s76, s76, s42
  s_add_u32 s77, s43, 0
  s_and_b32 s77, s77, 7
  s_lshl_b32 s77, s77, 12
  s_add_u32 s77, s77, s42
  s_add_u32 s77, s77, 32768
  s_add_u32 s78, s43, 2
  s_and_b32 s78, s78, 7
  s_lshl_b32 s78, s78, 12
  s_add_u32 s78, s78, s42
  s_add_u32 s78, s78, 32768
  s_add_u32 s79, s43, 4
  s_and_b32 s79, s79, 7
  s_lshl_b32 s79, s79, 12
  s_add_u32 s79, s79, s42
  s_add_u32 s79, s79, 32768
  s_add_u32 s80, s43, 6
  s_and_b32 s80, s80, 7
  s_lshl_b32 s80, s80, 12
  s_add_u32 s80, s80, s42
  s_add_u32 s80, s80, 32768
  s_add_u32 s81, s32, 0
  s_and_b32 s81, s81, 7
  s_lshl_b32 s81, s81, 16
  s_add_u32 s81, s81, s56
  s_add_u32 s82, s32, 1
  s_and_b32 s82, s82, 7
  s_lshl_b32 s82, s82, 16
  s_add_u32 s82, s82, s56
  s_add_u32 s83, s32, 2
  s_and_b32 s83, s83, 7
  s_lshl_b32 s83, s83, 16
  s_add_u32 s83, s83, s56
  s_add_u32 s84, s32, 3
  s_and_b32 s84, s84, 7
  s_lshl_b32 s84, s84, 16
  s_add_u32 s84, s84, s56
  s_add_u32 s85, s32, 4
  s_and_b32 s85, s85, 7
  s_lshl_b32 s85, s85, 16
  s_add_u32 s85, s85, s56
  s_add_u32 s86, s32, 5
  s_and_b32 s86, s86, 7
  s_lshl_b32 s86, s86, 16
  s_add_u32 s86, s86, s56
  s_add_u32 s87, s32, 6
  s_and_b32 s87, s87, 7
  s_lshl_b32 s87, s87, 16
  s_add_u32 s87, s87, s56
  s_add_u32 s88, s32, 7
  s_and_b32 s88, s88, 7
  s_lshl_b32 s88, s88, 16
  s_add_u32 s88, s88, s56
  s_lshl_b32 s72, s32, 7
  s_lshr_b32 s42, s33, 2
  s_lshl_b32 s42, s42, 6
  s_add_u32 s72, s72, s42
  s_lshl_b32 s72, s72, 11
  s_and_b32 s42, s33, 3
  s_lshl_b32 s42, s42, 8
  s_add_u32 s72, s72, s42
  s_add_u32 s72, s72, 1024
  s_add_u32 s101, s100, 1
  s_and_b32 s101, s101, 7
  s_mul_i32 s101, s101, 128
  s_add_u32 s40, s37, s101
  s_add_u32 m0, s55, 32768
  s_nop 0
  buffer_load_dwordx4 v2, s[4:7], s40 offen lds
  s_add_u32 s40, s40, 65536
  s_add_u32 m0, s55, 40960
  s_nop 0
  buffer_load_dwordx4 v2, s[4:7], s40 offen lds
  s_add_u32 s101, s100, 1
  s_and_b32 s101, s101, 7
  s_mul_i32 s101, s101, 196608
  s_add_u32 s40, s38, s101
  s_add_u32 s40, s40, 1024
  s_add_u32 m0, s55, 49152
  s_nop 0
  buffer_load_dwordx4 v3, s[8:11], s40 offen lds
  s_add_u32 s40, s40, 1024
  s_add_u32 m0, s55, 57344
  s_nop 0
  buffer_load_dwordx4 v3, s[8:11], s40 offen lds
  s_waitcnt vmcnt(4)
  s_cmp_eq_u32 s34, 0
  s_cbranch_scc0 P1_tg2
  v_mov_b32 v14, 133120
  ds_write_b32 v14, v16
  s_waitcnt lgkmcnt(0)
P1_tg2:
  v_add_u32 v112, 0, v5
  v_add_u32 v113, 0, v6
  v_add_u32 v114, 0, v7
  v_add_u32 v115, 0, v8
  v_add_u32 v116, 16384, v9
  s_barrier
  s_add_u32 s101, s100, 2
  s_and_b32 s101, s101, 7
  s_mul_i32 s101, s101, 128
  s_add_u32 s40, s37, s101
  s_add_u32 m0, s55, 65536
  s_nop 0
  buffer_load_dwordx4 v2, s[4:7], s40 offen lds
  v_mov_b32 v14, 133120
  ds_read_b32 v118, v14
  ds_read_b128 v[128:131], v112
  ds_read_b64_tr_b16 v[48:49], v116 offset:0
  ds_read_b64_tr_b16 v[50:51], v116 offset:512
  ds_read_b128 v[132:135], v113
  ds_read_b64_tr_b16 v[52:53], v116 offset:2048
  ds_read_b64_tr_b16 v[54:55], v116 offset:2560
  ds_read_b128 v[136:139], v114
  ds_read_b64_tr_b16 v[56:57], v116 offset:4096
  ds_read_b64_tr_b16 v[58:59], v116 offset:4608
  ds_read_b128 v[140:143], v115
  ds_read_b64_tr_b16 v[60:61], v116 offset:6144
  ds_read_b64_tr_b16 v[62:63], v116 offset:6656
  s_waitcnt lgkmcnt(12)
  v_readfirstlane_b32 s54, v118
  s_nop 3
  s_add_u32 s54, s54, 1
  s_and_b32 s96, s54, 1
  s_and_b32 s42, s54, 2
  s_lshl_b32 s42, s42, 15
  s_or_b32 s96, s96, s42
  s_and_b32 s25, s54, 0xff
  s_add_u32 s42, s54, 1
  s_and_b32 s42, s42, 0xff
  s_lshl_b32 s42, s42, 8
  s_or_b32 s25, s25, s42
  s_add_u32 s42, s54, 2
  s_and_b32 s42, s42, 0xff
  s_lshl_b32 s42, s42, 16
  s_or_b32 s25, s25, s42
  s_add_u32 s42, s54, 3
  s_and_b32 s42, s42, 0xff
  s_lshl_b32 s42, s42, 24
  s_or_b32 s25, s25, s42
  ds_read_b64_tr_b16 v[72:73], v116 offset:8192
  ds_read_b64_tr_b16 v[74:75], v116 offset:8704
  ds_read_b64_tr_b16 v[76:77], v116 offset:10240
  ds_read_b64_tr_b16 v[78:79], v116 offset:10752
  ds_read_b64_tr_b16 v[80:81], v116 offset:12288
  ds_read_b64_tr_b16 v[82:83], v116 offset:12800
  ds_read_b64_tr_b16 v[84:85], v116 offset:14336
  ds_read_b64_tr_b16 v[86:87], v116 offset:14848
  s_waitcnt lgkmcnt(15)
  v_mfma_f32_32x32x16_bf16 v[16:31], v[48:51], v[128:131], 0
  s_add_u32 s40, s40, 65536
  s_add_u32 m0, s55, 73728
  s_nop 0
  buffer_load_dwordx4 v2, s[4:7], s40 offen lds
  s_waitcnt lgkmcnt(14)
  v_mfma_f32_32x32x16_bf16 v[16:31], v[52:55], v[132:135], v[16:31]
  s_add_u32 s101, s100, 2
  s_and_b32 s101, s101, 7
  s_mul_i32 s101, s101, 196608
  s_add_u32 s40, s38, s101
  s_add_u32 s40, s40, 1024
  s_add_u32 m0, s55, 81920
  s_nop 0
  buffer_load_dwordx4 v3, s[8:11], s40 offen lds
  s_waitcnt lgkmcnt(11)
  v_mfma_f32_32x32x16_bf16 v[16:31], v[56:59], v[136:139], v[16:31]
  s_add_u32 s40, s40, 1024
  s_add_u32 m0, s55, 90112
  s_nop 0
  buffer_load_dwordx4 v3, s[8:11], s40 offen lds
  s_waitcnt lgkmcnt(8)
  v_mfma_f32_32x32x16_bf16 v[16:31], v[60:63], v[140:143], v[16:31]
  s_waitcnt vmcnt(4)
  v_add_u32 v112, 32768, v5
  v_add_u32 v113, 32768, v6
  v_add_u32 v114, 32768, v7
  v_add_u32 v115, 32768, v8
  v_add_u32 v116, 49152, v9
  s_barrier
  s_waitcnt lgkmcnt(6)
  v_mfma_f32_32x32x16_bf16 v[32:47], v[128:131], v[72:75], 0
  ds_read_b128 v[144:147], v112
  ds_read_b64_tr_b16 v[48:49], v116 offset:0
  ds_read_b64_tr_b16 v[50:51], v116 offset:512
  s_add_u32 s101, s100, 3
  s_and_b32 s101, s101, 7
  s_mul_i32 s101, s101, 128
  s_add_u32 s40, s37, s101
  s_add_u32 m0, s55, 98304
  s_nop 0
  buffer_load_dwordx4 v2, s[4:7], s40 offen lds
  s_waitcnt lgkmcnt(7)
  v_mfma_f32_32x32x16_bf16 v[32:47], v[132:135], v[76:79], v[32:47]
  ds_read_b128 v[148:151], v113
  ds_read_b64_tr_b16 v[52:53], v116 offset:2048
  ds_read_b64_tr_b16 v[54:55], v116 offset:2560
  s_add_u32 s40, s40, 65536
  s_add_u32 m0, s55, 106496
  s_nop 0
  buffer_load_dwordx4 v2, s[4:7], s40 offen lds
  s_waitcnt lgkmcnt(8)
  v_mfma_f32_32x32x16_bf16 v[32:47], v[136:139], v[80:83], v[32:47]
  ds_read_b128 v[152:155], v114
  ds_read_b64_tr_b16 v[56:57], v116 offset:4096
  ds_read_b64_tr_b16 v[58:59], v116 offset:4608
  s_waitcnt lgkmcnt(9)
  v_mfma_f32_32x32x16_bf16 v[32:47], v[140:143], v[84:87], v[32:47]
  ds_read_b128 v[156:159], v115
  ds_read_b64_tr_b16 v[60:61], v116 offset:6144
  ds_read_b64_tr_b16 v[62:63], v116 offset:6656
  s_waitcnt lgkmcnt(9)
  v_mfma_f32_32x32x16_bf16 v[16:31], v[48:51], v[144:147], v[16:31]
  ds_read_b64_tr_b16 v[72:73], v116 offset:8192
  ds_read_b64_tr_b16 v[74:75], v116 offset:8704
  s_add_u32 s101, s100, 3
  s_and_b32 s101, s101, 7
  s_mul_i32 s101, s101, 196608
  s_add_u32 s40, s38, s101
  s_add_u32 s40, s40, 1024
  s_add_u32 m0, s55, 114688
  s_nop 0
  buffer_load_dwordx4 v3, s[8:11], s40 offen lds
  s_waitcnt lgkmcnt(8)
  v_mfma_f32_32x32x16_bf16 v[16:31], v[52:55], v[148:151], v[16:31]
  ds_read_b64_tr_b16 v[76:77], v116 offset:10240
  ds_read_b64_tr_b16 v[78:79], v116 offset:10752
  s_add_u32 s40, s40, 1024
  s_add_u32 m0, s55, 122880
  s_nop 0
  buffer_load_dwordx4 v3, s[8:11], s40 offen lds
  s_waitcnt lgkmcnt(7)
  v_mfma_f32_32x32x16_bf16 v[16:31], v[56:59], v[152:155], v[16:31]
  ds_read_b64_tr_b16 v[80:81], v116 offset:12288
  ds_read_b64_tr_b16 v[82:83], v116 offset:12800
  s_waitcnt lgkmcnt(6)
  v_mfma_f32_32x32x16_bf16 v[16:31], v[60:63], v[156:159], v[16:31]
  ds_read_b64_tr_b16 v[84:85], v116 offset:14336
  ds_read_b64_tr_b16 v[86:87], v116 offset:14848
  s_waitcnt vmcnt(4)
  v_add_u32 v112, 65536, v5
  v_add_u32 v113, 65536, v6
  v_add_u32 v114, 65536, v7
  v_add_u32 v115, 65536, v8
  v_add_u32 v116, 81920, v9
  s_barrier
  s_waitcnt lgkmcnt(6)
  v_mfma_f32_32x32x16_bf16 v[32:47], v[144:147], v[72:75], v[32:47]
  ds_read_b128 v[160:163], v112
  ds_read_b64_tr_b16 v[48:49], v116 offset:0
  ds_read_b64_tr_b16 v[50:51], v116 offset:512
  s_add_u32 s101, s100, 4
  s_and_b32 s101, s101, 7
  s_mul_i32 s101, s101, 128
  s_add_u32 s40, s37, s101
  s_add_u32 m0, s55, 131072
  s_nop 0
  buffer_load_dwordx4 v2, s[4:7], s40 offen lds
  s_waitcnt lgkmcnt(7)
  v_mfma_f32_32x32x16_bf16 v[32:47], v[148:151], v[76:79], v[32:47]
  ds_read_b128 v[164:167], v113
  ds_read_b64_tr_b16 v[52:53], v116 offset:2048
  ds_read_b64_tr_b16 v[54:55], v116 offset:2560
  s_add_u32 s40, s40, 65536
  s_add_u32 m0, s55, 139264
  s_nop 0
  buffer_load_dwordx4 v2, s[4:7], s40 offen lds
  s_waitcnt lgkmcnt(8)
  v_mfma_f32_32x32x16_bf16 v[32:47], v[152:155], v[80:83], v[32:47]
  ds_read_b128 v[168:171], v114
  ds_read_b64_tr_b16 v[56:57], v116 offset:4096
  ds_read_b64_tr_b16 v[58:59], v116 offset:4608
  s_waitcnt lgkmcnt(9)
  v_mfma_f32_32x32x16_bf16 v[32:47], v[156:159], v[84:87], v[32:47]
  ds_read_b128 v[172:175], v115
  ds_read_b64_tr_b16 v[60:61], v116 offset:6144
  ds_read_b64_tr_b16 v[62:63], v116 offset:6656
  s_waitcnt lgkmcnt(9)
  v_mfma_f32_32x32x16_bf16 v[16:31], v[48:51], v[160:163], v[16:31]
  ds_read_b64_tr_b16 v[72:73], v116 offset:8192
  ds_read_b64_tr_b16 v[74:75], v116 offset:8704
  s_add_u32 s101, s100, 4
  s_and_b32 s101, s101, 7
  s_mul_i32 s101, s101, 196608
  s_add_u32 s40, s38, s101
  s_add_u32 s40, s40, 1024
  s_add_u32 m0, s55, 147456
  s_nop 0
  buffer_load_dwordx4 v3, s[8:11], s40 offen lds
  s_waitcnt lgkmcnt(8)
  v_mfma_f32_32x32x16_bf16 v[16:31], v[52:55], v[164:167], v[16:31]
  ds_read_b64_tr_b16 v[76:77], v116 offset:10240
  ds_read_b64_tr_b16 v[78:79], v116 offset:10752
  s_add_u32 s40, s40, 1024
  s_add_u32 m0, s55, 155648
  s_nop 0
  buffer_load_dwordx4 v3, s[8:11], s40 offen lds
  s_waitcnt lgkmcnt(7)
  v_mfma_f32_32x32x16_bf16 v[16:31], v[56:59], v[168:171], v[16:31]
  ds_read_b64_tr_b16 v[80:81], v116 offset:12288
  ds_read_b64_tr_b16 v[82:83], v116 offset:12800
  s_waitcnt lgkmcnt(6)
  v_mfma_f32_32x32x16_bf16 v[16:31], v[60:63], v[172:175], v[16:31]
  ds_read_b64_tr_b16 v[84:85], v116 offset:14336
  ds_read_b64_tr_b16 v[86:87], v116 offset:14848
  s_waitcnt vmcnt(4)
  v_add_u32 v112, 98304, v5
  v_add_u32 v113, 98304, v6
  v_add_u32 v114, 98304, v7
  v_add_u32 v115, 98304, v8
  v_add_u32 v116, 114688, v9
  s_barrier
  v_mov_b32 v88, -1
  s_waitcnt lgkmcnt(6)
  v_mfma_f32_32x32x16_bf16 v[32:47], v[160:163], v[72:75], v[32:47]
  ds_read_b128 v[176:179], v112
  ds_read_b64_tr_b16 v[48:49], v116 offset:0
  ds_read_b64_tr_b16 v[50:51], v116 offset:512
  s_add_u32 s101, s100, 5
  s_and_b32 s101, s101, 7
  s_mul_i32 s101, s101, 128
  s_add_u32 s40, s37, s101
  s_add_u32 m0, s55, 0
  s_nop 0
  buffer_load_dwordx4 v2, s[4:7], s40 offen lds
  s_waitcnt lgkmcnt(7)
  v_mfma_f32_32x32x16_bf16 v[32:47], v[164:167], v[76:79], v[32:47]
  ds_read_b128 v[180:183], v113
  ds_read_b64_tr_b16 v[52:53], v116 offset:2048
  ds_read_b64_tr_b16 v[54:55], v116 offset:2560
  s_add_u32 s40, s40, 65536
  s_add_u32 m0, s55, 8192
  s_nop 0
  buffer_load_dwordx4 v2, s[4:7], s40 offen lds
  s_waitcnt lgkmcnt(8)
  v_mfma_f32_32x32x16_bf16 v[32:47], v[168:171], v[80:83], v[32:47]
  ds_read_b128 v[184:187], v114
  ds_read_b64_tr_b16 v[56:57], v116 offset:4096
  ds_read_b64_tr_b16 v[58:59], v116 offset:4608
  s_waitcnt lgkmcnt(9)
  v_mfma_f32_32x32x16_bf16 v[32:47], v[172:175], v[84:87], v[32:47]
  ds_read_b128 v[188:191], v115
  ds_read_b64_tr_b16 v[60:61], v116 offset:6144
  ds_read_b64_tr_b16 v[62:63], v116 offset:6656
  s_waitcnt lgkmcnt(9)
  v_mfma_f32_32x32x16_bf16 v[16:31], v[48:51], v[176:179], v[16:31]
  ds_read_b64_tr_b16 v[72:73], v116 offset:8192
  ds_read_b64_tr_b16 v[74:75], v116 offset:8704
  s_add_u32 s101, s100, 5
  s_and_b32 s101, s101, 7
  s_mul_i32 s101, s101, 196608
  s_add_u32 s40, s38, s101
  s_add_u32 s40, s40, 1024
  s_add_u32 m0, s55, 16384
  s_nop 0
  buffer_load_dwordx4 v3, s[8:11], s40 offen lds
  s_waitcnt lgkmcnt(8)
  v_mfma_f32_32x32x16_bf16 v[16:31], v[52:55], v[180:183], v[16:31]
  ds_read_b64_tr_b16 v[76:77], v116 offset:10240
  ds_read_b64_tr_b16 v[78:79], v116 offset:10752
  s_add_u32 s40, s40, 1024
  s_add_u32 m0, s55, 24576
  s_nop 0
  buffer_load_dwordx4 v3, s[8:11], s40 offen lds
  s_waitcnt lgkmcnt(7)
  v_mfma_f32_32x32x16_bf16 v[16:31], v[56:59], v[184:187], v[16:31]
  ds_read_b64_tr_b16 v[80:81], v116 offset:12288
  ds_read_b64_tr_b16 v[82:83], v116 offset:12800
  s_cmp_eq_u32 s34, 7
  s_cbranch_scc0 P1_in3
  v_lshlrev_b32 v118, 2, v1
  s_lshr_b32 s42, s32, 3
  s_lshl_b32 s42, s42, 10
  s_and_b32 s43, s32, 7
  s_lshl_b32 s43, s43, 7
  s_mov_b32 exec_lo, -1
  s_mov_b32 exec_hi, 0
  s_add_u32 s42, s42, s43
  s_add_u32 s42, s42, s53
  buffer_store_dword v88, v118, s[16:19], s42 offen sc1
  s_mov_b64 exec, -1
  s_lshr_b32 s45, s32, 2
  s_lshl_b32 s45, s45, 5
  s_and_b32 s43, s32, 1
  s_lshl_b32 s43, s43, 4
  s_add_u32 s45, s45, s43
  s_and_b32 s43, s32, 2
  s_lshl_b32 s43, s43, 2
  s_add_u32 s45, s45, s43
  v_and_b32 v119, 1, v1
  v_lshlrev_b32 v119, 2, v119
  s_add_u32 s45, s45, s53
  s_add_u32 s45, s45, 4096
  s_mov_b64 exec, 3
  buffer_store_dword v88, v119, s[16:19], s45 offen sc1
  s_mov_b64 exec, -1
P1_in3:
  s_waitcnt lgkmcnt(6)
  v_mfma_f32_32x32x16_bf16 v[16:31], v[60:63], v[188:191], v[16:31]
  ds_read_b64_tr_b16 v[84:85], v116 offset:14336
  ds_read_b64_tr_b16 v[86:87], v116 offset:14848
  s_waitcnt vmcnt(4)
  v_add_u32 v112, 131072, v5
  v_add_u32 v113, 131072, v6
  v_add_u32 v114, 131072, v7
  v_add_u32 v115, 131072, v8
  v_add_u32 v116, 147456, v9
  s_barrier
  s_waitcnt lgkmcnt(6)
  v_mfma_f32_32x32x16_bf16 v[32:47], v[176:179], v[72:75], v[32:47]
  ds_read_b128 v[192:195], v112
  ds_read_b64_tr_b16 v[48:49], v116 offset:0
  ds_read_b64_tr_b16 v[50:51], v116 offset:512
  s_add_u32 s101, s100, 6
  s_and_b32 s101, s101, 7
  s_mul_i32 s101, s101, 128
  s_add_u32 s40, s37, s101
  s_add_u32 m0, s55, 32768
  s_nop 0
  buffer_load_dwordx4 v2, s[4:7], s40 offen lds
  s_waitcnt lgkmcnt(7)
  v_mfma_f32_32x32x16_bf16 v[32:47], v[180:183], v[76:79], v[32:47]
  ds_read_b128 v[196:199], v113
  ds_read_b64_tr_b16 v[52:53], v116 offset:2048
  ds_read_b64_tr_b16 v[54:55], v116 offset:2560
  s_add_u32 s40, s40, 65536
  s_add_u32 m0, s55, 40960
  s_nop 0
  buffer_load_dwordx4 v2, s[4:7], s40 offen lds
  s_waitcnt lgkmcnt(8)
  v_mfma_f32_32x32x16_bf16 v[32:47], v[184:187], v[80:83], v[32:47]
  ds_read_b128 v[200:203], v114
  ds_read_b64_tr_b16 v[56:57], v116 offset:4096
  ds_read_b64_tr_b16 v[58:59], v116 offset:4608
  s_waitcnt lgkmcnt(9)
  v_mfma_f32_32x32x16_bf16 v[32:47], v[188:191], v[84:87], v[32:47]
  ds_read_b128 v[204:207], v115
  ds_read_b64_tr_b16 v[60:61], v116 offset:6144
  ds_read_b64_tr_b16 v[62:63], v116 offset:6656
  s_waitcnt lgkmcnt(9)
  v_mfma_f32_32x32x16_bf16 v[16:31], v[48:51], v[192:195], v[16:31]
  ds_read_b64_tr_b16 v[72:73], v116 offset:8192
  ds_read_b64_tr_b16 v[74:75], v116 offset:8704
  s_add_u32 s101, s100, 6
  s_and_b32 s101, s101, 7
  s_mul_i32 s101, s101, 196608
  s_add_u32 s40, s38, s101
  s_add_u32 s40, s40, 1024
  s_add_u32 m0, s55, 49152
  s_nop 0
  buffer_load_dwordx4 v3, s[8:11], s40 offen lds
  s_waitcnt lgkmcnt(8)
  v_mfma_f32_32x32x16_bf16 v[16:31], v[52:55], v[196:199], v[16:31]
  ds_read_b64_tr_b16 v[76:77], v116 offset:10240
  ds_read_b64_tr_b16 v[78:79], v116 offset:10752
  s_add_u32 s40, s40, 1024
  s_add_u32 m0, s55, 57344
  s_nop 0
  buffer_load_dwordx4 v3, s[8:11], s40 offen lds
  s_waitcnt lgkmcnt(7)
  v_mfma_f32_32x32x16_bf16 v[16:31], v[56:59], v[200:203], v[16:31]
  ds_read_b64_tr_b16 v[80:81], v116 offset:12288
  ds_read_b64_tr_b16 v[82:83], v116 offset:12800
  s_waitcnt lgkmcnt(6)
  v_mfma_f32_32x32x16_bf16 v[16:31], v[60:63], v[204:207], v[16:31]
  ds_read_b64_tr_b16 v[84:85], v116 offset:14336
  ds_read_b64_tr_b16 v[86:87], v116 offset:14848
  s_waitcnt vmcnt(4)
  v_add_u32 v112, 0, v5
  v_add_u32 v113, 0, v6
  v_add_u32 v114, 0, v7
  v_add_u32 v115, 0, v8
  v_add_u32 v116, 16384, v9
  s_barrier
  s_waitcnt lgkmcnt(6)
  v_mfma_f32_32x32x16_bf16 v[32:47], v[192:195], v[72:75], v[32:47]
  ds_read_b128 v[208:211], v112
  ds_read_b64_tr_b16 v[48:49], v116 offset:0
  ds_read_b64_tr_b16 v[50:51], v116 offset:512
  s_add_u32 s101, s100, 7
  s_and_b32 s101, s101, 7
  s_mul_i32 s101, s101, 128
  s_add_u32 s40, s37, s101
  s_add_u32 m0, s55, 65536
  s_nop 0
  buffer_load_dwordx4 v2, s[4:7], s40 offen lds
  s_waitcnt lgkmcnt(7)
  v_mfma_f32_32x32x16_bf16 v[32:47], v[196:199], v[76:79], v[32:47]
  ds_read_b128 v[212:215], v113
  ds_read_b64_tr_b16 v[52:53], v116 offset:2048
  ds_read_b64_tr_b16 v[54:55], v116 offset:2560
  s_add_u32 s40, s40, 65536
  s_add_u32 m0, s55, 73728
  s_nop 0
  buffer_load_dwordx4 v2, s[4:7], s40 offen lds
  s_waitcnt lgkmcnt(8)
  v_mfma_f32_32x32x16_bf16 v[32:47], v[200:203], v[80:83], v[32:47]
  ds_read_b128 v[216:219], v114
  ds_read_b64_tr_b16 v[56:57], v116 offset:4096
  ds_read_b64_tr_b16 v[58:59], v116 offset:4608
  s_waitcnt lgkmcnt(9)
  v_mfma_f32_32x32x16_bf16 v[32:47], v[204:207], v[84:87], v[32:47]
  ds_read_b128 v[220:223], v115
  ds_read_b64_tr_b16 v[60:61], v116 offset:6144
  ds_read_b64_tr_b16 v[62:63], v116 offset:6656
  s_waitcnt lgkmcnt(9)
  v_mfma_f32_32x32x16_bf16 v[16:31], v[48:51], v[208:211], v[16:31]
  ds_read_b64_tr_b16 v[72:73], v116 offset:8192
  ds_read_b64_tr_b16 v[74:75], v116 offset:8704
  s_add_u32 s101, s100, 7
  s_and_b32 s101, s101, 7
  s_mul_i32 s101, s101, 196608
  s_add_u32 s40, s38, s101
  s_add_u32 s40, s40, 1024
  s_add_u32 m0, s55, 81920
  s_nop 0
  buffer_load_dwordx4 v3, s[8:11], s40 offen lds
  s_waitcnt lgkmcnt(8)
  v_mfma_f32_32x32x16_bf16 v[16:31], v[52:55], v[212:215], v[16:31]
  ds_read_b64_tr_b16 v[76:77], v116 offset:10240
  ds_read_b64_tr_b16 v[78:79], v116 offset:10752
  s_add_u32 s40, s40, 1024
  s_add_u32 m0, s55, 90112
  s_nop 0
  buffer_load_dwordx4 v3, s[8:11], s40 offen lds
  s_waitcnt lgkmcnt(7)
  v_mfma_f32_32x32x16_bf16 v[16:31], v[56:59], v[216:219], v[16:31]
  ds_read_b64_tr_b16 v[80:81], v116 offset:12288
  ds_read_b64_tr_b16 v[82:83], v116 offset:12800
  s_waitcnt lgkmcnt(6)
  v_mfma_f32_32x32x16_bf16 v[16:31], v[60:63], v[220:223], v[16:31]
  ds_read_b64_tr_b16 v[84:85], v116 offset:14336
  ds_read_b64_tr_b16 v[86:87], v116 offset:14848
  s_waitcnt vmcnt(4)
  v_add_u32 v112, 32768, v5
  v_add_u32 v113, 32768, v6
  v_add_u32 v114, 32768, v7
  v_add_u32 v115, 32768, v8
  v_add_u32 v116, 49152, v9
  s_barrier
  s_waitcnt lgkmcnt(6)
  v_mfma_f32_32x32x16_bf16 v[32:47], v[208:211], v[72:75], v[32:47]
  ds_read_b128 v[224:227], v112
  ds_read_b64_tr_b16 v[48:49], v116 offset:0
  ds_read_b64_tr_b16 v[50:51], v116 offset:512
  s_add_u32 s101, s100, 0
  s_and_b32 s101, s101, 7
  s_mul_i32 s101, s101, 196608
  s_add_u32 s40, s38, s101
  s_add_u32 m0, s55, 98304
  s_nop 0
  buffer_load_dwordx4 v3, s[8:11], s40 offen lds
  s_waitcnt lgkmcnt(7)
  v_mfma_f32_32x32x16_bf16 v[32:47], v[212:215], v[76:79], v[32:47]
  ds_read_b128 v[228:231], v113
  ds_read_b64_tr_b16 v[52:53], v116 offset:2048
  ds_read_b64_tr_b16 v[54:55], v116 offset:2560
  s_add_u32 s101, s100, 1
  s_and_b32 s101, s101, 7
  s_mul_i32 s101, s101, 196608
  s_add_u32 s40, s38, s101
  s_add_u32 m0, s55, 106496
  s_nop 0
  buffer_load_dwordx4 v3, s[8:11], s40 offen lds
  s_waitcnt lgkmcnt(8)
  v_mfma_f32_32x32x16_bf16 v[32:47], v[216:219], v[80:83], v[32:47]
  ds_read_b128 v[232:235], v114
  ds_read_b64_tr_b16 v[56:57], v116 offset:4096
  ds_read_b64_tr_b16 v[58:59], v116 offset:4608
  s_waitcnt lgkmcnt(9)
  v_mfma_f32_32x32x16_bf16 v[32:47], v[220:223], v[84:87], v[32:47]
  ds_read_b128 v[236:239], v115
  ds_read_b64_tr_b16 v[60:61], v116 offset:6144
  ds_read_b64_tr_b16 v[62:63], v116 offset:6656
  s_waitcnt lgkmcnt(9)
  v_mfma_f32_32x32x16_bf16 v[16:31], v[48:51], v[224:227], v[16:31]
  ds_read_b64_tr_b16 v[72:73], v116 offset:8192
  ds_read_b64_tr_b16 v[74:75], v116 offset:8704
  s_add_u32 s101, s100, 2
  s_and_b32 s101, s101, 7
  s_mul_i32 s101, s101, 196608
  s_add_u32 s40, s38, s101
  s_add_u32 m0, s55, 114688
  s_nop 0
  buffer_load_dwordx4 v3, s[8:11], s40 offen lds
  s_waitcnt lgkmcnt(8)
  v_mfma_f32_32x32x16_bf16 v[16:31], v[52:55], v[228:231], v[16:31]
  ds_read_b64_tr_b16 v[76:77], v116 offset:10240
  ds_read_b64_tr_b16 v[78:79], v116 offset:10752
  s_add_u32 s101, s100, 3
  s_and_b32 s101, s101, 7
  s_mul_i32 s101, s101, 196608
  s_add_u32 s40, s38, s101
  s_add_u32 m0, s55, 122880
  s_nop 0
  buffer_load_dwordx4 v3, s[8:11], s40 offen lds
  s_waitcnt lgkmcnt(7)
  v_mfma_f32_32x32x16_bf16 v[16:31], v[56:59], v[232:235], v[16:31]
  ds_read_b64_tr_b16 v[80:81], v116 offset:12288
  ds_read_b64_tr_b16 v[82:83], v116 offset:12800
  s_waitcnt lgkmcnt(6)
  v_mfma_f32_32x32x16_bf16 v[16:31], v[60:63], v[236:239], v[16:31]
  ds_read_b64_tr_b16 v[84:85], v116 offset:14336
  ds_read_b64_tr_b16 v[86:87], v116 offset:14848
  s_waitcnt vmcnt(4)
  v_add_u32 v112, 65536, v5
  v_add_u32 v113, 65536, v6
  v_add_u32 v114, 65536, v7
  v_add_u32 v115, 65536, v8
  v_add_u32 v116, 81920, v9
  s_barrier
  s_waitcnt lgkmcnt(6)
  v_mfma_f32_32x32x16_bf16 v[32:47], v[224:227], v[72:75], v[32:47]
  ds_read_b128 v[240:243], v112
  ds_read_b64_tr_b16 v[48:49], v116 offset:0
  ds_read_b64_tr_b16 v[50:51], v116 offset:512
  s_add_u32 s101, s100, 4
  s_and_b32 s101, s101, 7
  s_mul_i32 s101, s101, 196608
  s_add_u32 s40, s38, s101
  s_add_u32 m0, s55, 131072
  s_nop 0
  buffer_load_dwordx4 v3, s[8:11], s40 offen lds
  s_waitcnt lgkmcnt(7)
  v_mfma_f32_32x32x16_bf16 v[32:47], v[228:231], v[76:79], v[32:47]
  ds_read_b128 v[244:247], v113
  ds_read_b64_tr_b16 v[52:53], v116 offset:2048
  ds_read_b64_tr_b16 v[54:55], v116 offset:2560
  s_add_u32 s101, s100, 5
  s_and_b32 s101, s101, 7
  s_mul_i32 s101, s101, 196608
  s_add_u32 s40, s38, s101
  s_add_u32 m0, s55, 139264
  s_nop 0
  buffer_load_dwordx4 v3, s[8:11], s40 offen lds
  s_waitcnt lgkmcnt(8)
  v_mfma_f32_32x32x16_bf16 v[32:47], v[232:235], v[80:83], v[32:47]
  ds_read_b128 v[248:251], v114
  ds_read_b64_tr_b16 v[56:57], v116 offset:4096
  ds_read_b64_tr_b16 v[58:59], v116 offset:4608
  s_waitcnt lgkmcnt(9)
  v_mfma_f32_32x32x16_bf16 v[32:47], v[236:239], v[84:87], v[32:47]
  ds_read_b128 v[252:255], v115
  ds_read_b64_tr_b16 v[60:61], v116 offset:6144
  ds_read_b64_tr_b16 v[62:63], v116 offset:6656
  s_waitcnt lgkmcnt(9)
  v_mfma_f32_32x32x16_bf16 v[16:31], v[48:51], v[240:243], v[16:31]
  ds_read_b64_tr_b16 v[72:73], v116 offset:8192
  ds_read_b64_tr_b16 v[74:75], v116 offset:8704
  s_add_u32 s101, s100, 6
  s_and_b32 s101, s101, 7
  s_mul_i32 s101, s101, 196608
  s_add_u32 s40, s38, s101
  s_add_u32 m0, s55, 147456
  s_nop 0
  buffer_load_dwordx4 v3, s[8:11], s40 offen lds
  s_waitcnt lgkmcnt(8)
  v_mfma_f32_32x32x16_bf16 v[16:31], v[52:55], v[244:247], v[16:31]
  ds_read_b64_tr_b16 v[76:77], v116 offset:10240
  ds_read_b64_tr_b16 v[78:79], v116 offset:10752
  s_add_u32 s101, s100, 7
  s_and_b32 s101, s101, 7
  s_mul_i32 s101, s101, 196608
  s_add_u32 s40, s38, s101
  s_add_u32 m0, s55, 155648
  s_nop 0
  buffer_load_dwordx4 v3, s[8:11], s40 offen lds
  s_waitcnt lgkmcnt(7)
  v_mfma_f32_32x32x16_bf16 v[16:31], v[56:59], v[248:251], v[16:31]
  ds_read_b64_tr_b16 v[80:81], v116 offset:12288
  ds_read_b64_tr_b16 v[82:83], v116 offset:12800
  s_waitcnt lgkmcnt(6)
  v_mfma_f32_32x32x16_bf16 v[16:31], v[60:63], v[252:255], v[16:31]
  ds_read_b64_tr_b16 v[84:85], v116 offset:14336
  ds_read_b64_tr_b16 v[86:87], v116 offset:14848
  v_lshrrev_b32 v0, 2, v1
  v_mul_u32_u24 v0, 9216, v0
  v_mov_b32 v117, v0
  v_and_b32 v14, 1, v1
  v_lshlrev_b32 v2, 4, v14
  v_add_u32 v0, v0, v2
  v_bfe_u32 v14, v1, 1, 1
  v_lshl_add_u32 v0, v14, 10, v0
  v_lshl_add_u32 v2, v14, 3, v2
  v_and_b32 v124, 15, v1
  s_lshl_b32 s41, s33, 4
  v_add_u32 v124, s41, v124
  v_and_b32 v14, 7, v1
  v_lshlrev_b32 v14, 4, v14
  v_add_u32 v14, s32, v14
  s_mov_b64 exec, s[48:49]
  v_mov_b32 v124, v14
  s_mov_b64 exec, -1
  v_lshlrev_b32 v124, 7, v124
  s_lshl_b32 s41, s36, 13
  v_add_u32 v120, s41, v10
  v_xor_b32 v121, 16, v120
  v_xor_b32 v122, 32, v120
  v_xor_b32 v123, 48, v120
  v_add_u32 v112, s70, v11
  v_add_u32 v113, s70, v12
  v_add_u32 v114, s71, v13
  s_bfe_u32 s41, s25, 0x80000
  v_mov_b32 v5, s41
  s_bfe_u32 s41, s25, 0x80008
  v_mov_b32 v6, s41
  s_bfe_u32 s41, s25, 0x80010
  v_mov_b32 v7, s41
  s_bfe_u32 s41, s25, 0x80018
  v_mov_b32 v8, s41
  v_and_b32 v14, 3, v1
  v_lshlrev_b32 v14, 3, v14
  v_mov_b32 v116, s25
  v_lshrrev_b32 v116, v14, v116
  v_and_b32 v116, 0xff, v116
  v_lshrrev_b32 v3, 5, v1
  v_lshlrev_b32 v3, 4, v3
  v_bfe_u32 v14, v1, 4, 1
  v_xor_b32 v14, 1, v14
  v_lshl_add_u32 v3, v14, 5, v3
  s_waitcnt lgkmcnt(6)
  v_mfma_f32_32x32x16_bf16 v[32:47], v[240:243], v[72:75], v[32:47]
  s_waitcnt lgkmcnt(4)
  v_mfma_f32_32x32x16_bf16 v[32:47], v[244:247], v[76:79], v[32:47]
  s_waitcnt lgkmcnt(2)
  v_mfma_f32_32x32x16_bf16 v[32:47], v[248:251], v[80:83], v[32:47]
  s_waitcnt lgkmcnt(0)
  v_mfma_f32_32x32x16_bf16 v[32:47], v[252:255], v[84:87], v[32:47]
  s_barrier
  s_cmp_eq_u32 s34, 0
  s_cbranch_scc0 P1_fl4
  s_lshl_b32 s42, s33, 4
  s_add_u32 s42, s42, s32
  s_lshl_b32 s42, s42, 7
  s_add_u32 s42, s42, 20480
  v_mov_b32 v14, 0
  v_mov_b32 v15, s54
  s_mov_b64 exec, 1
  buffer_store_dword v15, v14, s[16:19], s42 offen sc1
  s_mov_b64 exec, -1
P1_fl4:
  v_mul_f32 v88, v126, v16
  s_add_u32 m0, s55, 49152
  s_add_u32 s40, s81, 32768
  buffer_load_dwordx4 v4, s[12:15], s81 offen lds
  s_add_u32 m0, s55, 57344
  s_nop 0
  buffer_load_dwordx4 v4, s[12:15], s40 offen lds
  v_mul_f32 v89, v126, v17
  v_mul_f32 v90, v126, v18
  v_mul_f32 v91, v126, v19
  v_mul_f32 v92, v126, v20
  v_mul_f32 v93, v126, v21
  v_mul_f32 v94, v126, v22
  v_mul_f32 v95, v126, v23
  v_mul_f32 v96, v126, v24
  v_mul_f32 v97, v126, v25
  v_mul_f32 v98, v126, v26
  v_mul_f32 v99, v126, v27
  v_mul_f32 v100, v126, v28
  v_mul_f32 v101, v126, v29
  v_mul_f32 v102, v126, v30
  v_mul_f32 v103, v126, v31
  v_min_f32 v88, 0, v88
  v_min_f32 v89, 0, v89
  v_min_f32 v90, 0, v90
  v_min_f32 v91, 0, v91
  v_min_f32 v92, 0, v92
  v_min_f32 v93, 0, v93
  v_min_f32 v94, 0, v94
  v_min_f32 v95, 0, v95
  v_min_f32 v96, 0, v96
  v_min_f32 v97, 0, v97
  v_min_f32 v98, 0, v98
  v_min_f32 v99, 0, v99
  v_min_f32 v100, 0, v100
  s_add_u32 m0, s55, 65536
  s_add_u32 s40, s82, 32768
  buffer_load_dwordx4 v4, s[12:15], s82 offen lds
  s_add_u32 m0, s55, 73728
  s_nop 0
  buffer_load_dwordx4 v4, s[12:15], s40 offen lds
  v_min_f32 v101, 0, v101
  v_min_f32 v102, 0, v102
  v_min_f32 v103, 0, v103
  v_exp_f32 v88, v88
  v_max_f32 v16, 0, v16
  v_exp_f32 v89, v89
  v_max_f32 v17, 0, v17
  v_exp_f32 v90, v90
  v_max_f32 v18, 0, v18
  v_exp_f32 v91, v91
  v_max_f32 v19, 0, v19
  v_exp_f32 v92, v92
  v_max_f32 v20, 0, v20
  v_exp_f32 v93, v93
  v_max_f32 v21, 0, v21
  v_exp_f32 v94, v94
  v_max_f32 v22, 0, v22
  v_exp_f32 v95, v95
  v_max_f32 v23, 0, v23
  v_exp_f32 v96, v96
  v_max_f32 v24, 0, v24
  v_exp_f32 v97, v97
  v_max_f32 v25, 0, v25
  v_exp_f32 v98, v98
  v_max_f32 v26, 0, v26
  v_exp_f32 v99, v99
  v_max_f32 v27, 0, v27
  v_exp_f32 v100, v100
  v_max_f32 v28, 0, v28
  s_add_u32 m0, s55, 81920
  s_add_u32 s40, s83, 32768
  buffer_load_dwordx4 v4, s[12:15], s83 offen lds
  s_add_u32 m0, s55, 90112
  s_nop 0
  buffer_load_dwordx4 v4, s[12:15], s40 offen lds
  v_exp_f32 v101, v101
  v_max_f32 v29, 0, v29
  v_exp_f32 v102, v102
  v_max_f32 v30, 0, v30
  v_exp_f32 v103, v103
  v_max_f32 v31, 0, v31
  v_add_f32 v16, v127, v16
  v_add_f32 v17, v127, v17
  v_add_f32 v18, v127, v18
  v_add_f32 v19, v127, v19
  v_add_f32 v20, v127, v20
  v_add_f32 v21, v127, v21
  v_add_f32 v22, v127, v22
  v_add_f32 v23, v127, v23
  v_add_f32 v24, v127, v24
  v_add_f32 v25, v127, v25
  v_add_f32 v26, v127, v26
  v_add_f32 v27, v127, v27
  v_add_f32 v28, v127, v28
  v_add_f32 v29, v127, v29
  v_add_f32 v30, v127, v30
  v_add_f32 v31, v127, v31
  v_add_f32 v88, v88, v16
  v_add_f32 v89, v89, v17
  v_add_f32 v90, v90, v18
  v_add_f32 v91, v91, v19
  v_add_f32 v92, v92, v20
  v_add_f32 v93, v93, v21
  v_add_f32 v94, v94, v22
  v_add_f32 v95, v95, v23
  v_add_f32 v96, v96, v24
  v_add_f32 v97, v97, v25
  v_add_f32 v98, v98, v26
  v_add_f32 v99, v99, v27
  v_add_f32 v100, v100, v28
  v_add_f32 v101, v101, v29
  v_add_f32 v102, v102, v30
  v_add_f32 v103, v103, v31
  v_cvt_pk_bf16_f32 v16, v88, v89
  v_cvt_pk_bf16_f32 v17, v90, v91
  v_cvt_pk_bf16_f32 v18, v92, v93
  v_cvt_pk_bf16_f32 v19, v94, v95
  v_cvt_pk_bf16_f32 v20, v96, v97
  v_cvt_pk_bf16_f32 v21, v98, v99
  v_cvt_pk_bf16_f32 v22, v100, v101
  v_cvt_pk_bf16_f32 v23, v102, v103
  ds_write_b64 v120, v[16:17] offset:0
  ds_write_b64 v121, v[18:19] offset:0
  ds_write_b64 v122, v[20:21] offset:0
  ds_write_b64 v123, v[22:23] offset:0
  v_cvt_pk_bf16_f32 v48, v32, v33
  v_cvt_pk_bf16_f32 v49, v34, v35
  v_cvt_pk_bf16_f32 v50, v36, v37
  v_cvt_pk_bf16_f32 v51, v38, v39
  v_cvt_pk_bf16_f32 v52, v40, v41
  v_cvt_pk_bf16_f32 v53, v42, v43
  v_cvt_pk_bf16_f32 v54, v44, v45
  v_cvt_pk_bf16_f32 v55, v46, v47
  s_lshl_b32 s41, s34, 11
  v_add_u32 v115, s41, v13
  v_add_u32 v115, 32768, v115
  ds_write_b128 v115, v[48:51]
  ds_write_b128 v115, v[52:55] offset:1024
  s_waitcnt lgkmcnt(0)
  s_barrier
  s_bitcmp1_b32 s34, 1
  s_cbranch_scc1 P1_kz5
  ds_read_b64_tr_b16 v[72:73], v112 offset:0
  ds_read_b64_tr_b16 v[74:75], v113 offset:0
  ds_read_b128 v[88:91], v114 offset:0
  ds_read_b64_tr_b16 v[76:77], v112 offset:1024
  ds_read_b64_tr_b16 v[78:79], v113 offset:1024
  ds_read_b128 v[92:95], v114 offset:1024
  ds_read_b64_tr_b16 v[80:81], v112 offset:2048
  ds_read_b64_tr_b16 v[82:83], v113 offset:2048
  ds_read_b128 v[96:99], v114 offset:2048
  ds_read_b64_tr_b16 v[84:85], v112 offset:3072
  ds_read_b64_tr_b16 v[86:87], v113 offset:3072
  ds_read_b128 v[100:103], v114 offset:3072
  ds_read_b64_tr_b16 v[16:17], v112 offset:4096
  ds_read_b64_tr_b16 v[18:19], v113 offset:4096
  ds_read_b128 v[48:51], v114 offset:4096
  s_waitcnt lgkmcnt(12)
  v_mfma_f32_32x32x16_bf16 v[32:47], v[72:75], v[88:91], 0
  ds_read_b64_tr_b16 v[20:21], v112 offset:5120
  ds_read_b64_tr_b16 v[22:23], v113 offset:5120
  ds_read_b128 v[52:55], v114 offset:5120
  s_waitcnt lgkmcnt(12)
  v_mfma_f32_32x32x16_bf16 v[32:47], v[76:79], v[92:95], v[32:47]
  ds_read_b64_tr_b16 v[24:25], v112 offset:6144
  ds_read_b64_tr_b16 v[26:27], v113 offset:6144
  ds_read_b128 v[56:59], v114 offset:6144
  s_waitcnt lgkmcnt(12)
  v_mfma_f32_32x32x16_bf16 v[32:47], v[80:83], v[96:99], v[32:47]
  ds_read_b64_tr_b16 v[28:29], v112 offset:7168
  ds_read_b64_tr_b16 v[30:31], v113 offset:7168
  ds_read_b128 v[60:63], v114 offset:7168
  s_waitcnt lgkmcnt(12)
  v_mfma_f32_32x32x16_bf16 v[32:47], v[84:87], v[100:103], v[32:47]
  s_waitcnt lgkmcnt(9)
  v_mfma_f32_32x32x16_bf16 v[32:47], v[16:19], v[48:51], v[32:47]
  s_waitcnt lgkmcnt(6)
  v_mfma_f32_32x32x16_bf16 v[32:47], v[20:23], v[52:55], v[32:47]
  s_waitcnt lgkmcnt(3)
  v_mfma_f32_32x32x16_bf16 v[32:47], v[24:27], v[56:59], v[32:47]
  s_waitcnt lgkmcnt(0)
  v_mfma_f32_32x32x16_bf16 v[32:47], v[28:31], v[60:63], v[32:47]
  s_branch P1_kj6
P1_kz5:
  v_mov_b32 v88, 0x3f803f80
  v_mov_b32 v89, 0x3f803f80
  v_mov_b32 v90, 0x3f803f80
  v_mov_b32 v91, 0x3f803f80
  ds_read_b64_tr_b16 v[72:73], v112 offset:0
  ds_read_b64_tr_b16 v[74:75], v113 offset:0
  ds_read_b64_tr_b16 v[76:77], v112 offset:1024
  ds_read_b64_tr_b16 v[78:79], v113 offset:1024
  ds_read_b64_tr_b16 v[80:81], v112 offset:2048
  ds_read_b64_tr_b16 v[82:83], v113 offset:2048
  ds_read_b64_tr_b16 v[84:85], v112 offset:3072
  ds_read_b64_tr_b16 v[86:87], v113 offset:3072
  ds_read_b64_tr_b16 v[16:17], v112 offset:4096
  ds_read_b64_tr_b16 v[18:19], v113 offset:4096
  ds_read_b64_tr_b16 v[20:21], v112 offset:5120
  ds_read_b64_tr_b16 v[22:23], v113 offset:5120
  ds_read_b64_tr_b16 v[24:25], v112 offset:6144
  ds_read_b64_tr_b16 v[26:27], v113 offset:6144
  ds_read_b64_tr_b16 v[28:29], v112 offset:7168
  ds_read_b64_tr_b16 v[30:31], v113 offset:7168
  s_waitcnt lgkmcnt(14)
  v_mfma_f32_32x32x16_bf16 v[32:47], v[88:91], v[72:75], 0
  s_waitcnt lgkmcnt(12)
  v_mfma_f32_32x32x16_bf16 v[32:47], v[88:91], v[76:79], v[32:47]
  s_waitcnt lgkmcnt(10)
  v_mfma_f32_32x32x16_bf16 v[32:47], v[88:91], v[80:83], v[32:47]
  s_waitcnt lgkmcnt(8)
  v_mfma_f32_32x32x16_bf16 v[32:47], v[88:91], v[84:87], v[32:47]
  s_waitcnt lgkmcnt(6)
  v_mfma_f32_32x32x16_bf16 v[32:47], v[88:91], v[16:19], v[32:47]
  s_waitcnt lgkmcnt(4)
  v_mfma_f32_32x32x16_bf16 v[32:47], v[88:91], v[20:23], v[32:47]
  s_waitcnt lgkmcnt(2)
  v_mfma_f32_32x32x16_bf16 v[32:47], v[88:91], v[24:27], v[32:47]
  s_waitcnt lgkmcnt(0)
  v_mfma_f32_32x32x16_bf16 v[32:47], v[88:91], v[28:31], v[32:47]
P1_kj6:
  s_nop 11
  s_nop 1
  s_cmp_ge_u32 s34, 4
  s_cbranch_scc1 P1_pj8
  s_bitcmp1_b32 s34, 1
  s_cbranch_scc1 P1_pz7
  s_mov_b64 exec, s[48:49]
  v_mov_b32 v32, v40
  v_mov_b32 v33, v41
  v_mov_b32 v34, v42
  v_mov_b32 v35, v43
  v_mov_b32 v36, v44
  v_mov_b32 v37, v45
  v_mov_b32 v38, v46
  v_mov_b32 v39, v47
  s_mov_b64 exec, -1
  s_mov_b32 s44, 0xffffff00
  v_and_or_b32 v32, v32, s44, v5
  v_and_or_b32 v33, v33, s44, v6
  v_and_or_b32 v34, v34, s44, v7
  v_and_or_b32 v35, v35, s44, v8
  v_and_or_b32 v36, v36, s44, v5
  v_and_or_b32 v37, v37, s44, v6
  v_and_or_b32 v38, v38, s44, v7
  v_and_or_b32 v39, v39, s44, v8
  s_mov_b32 s42, s69
  buffer_store_dwordx4 v[32:35], v13, s[16:19], s42 offen offset:0 sc1
  buffer_store_dwordx4 v[36:39], v13, s[16:19], s42 offen offset:1024 sc1
  s_branch P1_pj8
P1_pz7:
  s_mov_b32 s42, s69
  s_mov_b32 s44, 0xffffff00
  v_and_or_b32 v32, v32, s44, v116
  v_lshlrev_b32 v112, 2, v1
  s_mov_b32 exec_lo, -1
  s_mov_b32 exec_hi, 0
  buffer_store_dword v32, v112, s[16:19], s42 offen sc1
  s_mov_b64 exec, -1
P1_pj8:
  v_add_u32 v114, 98304, v9
  s_waitcnt vmcnt(6)
  s_barrier
  ds_read_b64_tr_b16 v[48:49], v114 offset:0
  ds_read_b64_tr_b16 v[50:51], v114 offset:512
  ds_read_b64_tr_b16 v[52:53], v114 offset:2048
  ds_read_b64_tr_b16 v[54:55], v114 offset:2560
  s_waitcnt lgkmcnt(2)
  v_mfma_f32_32x32x16_bf16 v[16:31], v[48:51], v[128:131], 0
  ds_read_b64_tr_b16 v[56:57], v114 offset:4096
  ds_read_b64_tr_b16 v[58:59], v114 offset:4608
  s_waitcnt lgkmcnt(2)
  v_mfma_f32_32x32x16_bf16 v[16:31], v[52:55], v[132:135], v[16:31]
  ds_read_b64_tr_b16 v[60:61], v114 offset:6144
  ds_read_b64_tr_b16 v[62:63], v114 offset:6656
  s_mov_b32 s41, 20480
  buffer_load_dword v125, v124, s[16:19], s41 offen sc1
  s_waitcnt lgkmcnt(2)
  v_mfma_f32_32x32x16_bf16 v[16:31], v[56:59], v[136:139], v[16:31]
  ds_read_b64_tr_b16 v[48:49], v114 offset:8192
  ds_read_b64_tr_b16 v[50:51], v114 offset:8704
  s_waitcnt lgkmcnt(2)
  v_mfma_f32_32x32x16_bf16 v[16:31], v[60:63], v[140:143], v[16:31]
  ds_read_b64_tr_b16 v[52:53], v114 offset:10240
  ds_read_b64_tr_b16 v[54:55], v114 offset:10752
  s_waitcnt lgkmcnt(2)
  v_mfma_f32_32x32x16_bf16 v[16:31], v[48:51], v[144:147], v[16:31]
  ds_read_b64_tr_b16 v[56:57], v114 offset:12288
  ds_read_b64_tr_b16 v[58:59], v114 offset:12800
  s_waitcnt lgkmcnt(2)
  v_mfma_f32_32x32x16_bf16 v[16:31], v[52:55], v[148:151], v[16:31]
  ds_read_b64_tr_b16 v[60:61], v114 offset:14336
  ds_read_b64_tr_b16 v[62:63], v114 offset:14848
  s_waitcnt lgkmcnt(2)
  v_mfma_f32_32x32x16_bf16 v[16:31], v[56:59], v[152:155], v[16:31]
  ds_read_b64_tr_b16 v[48:49], v114 offset:16384
  ds_read_b64_tr_b16 v[50:51], v114 offset:16896
  s_waitcnt lgkmcnt(2)
  v_mfma_f32_32x32x16_bf16 v[16:31], v[60:63], v[156:159], v[16:31]
  ds_read_b64_tr_b16 v[52:53], v114 offset:18432
  ds_read_b64_tr_b16 v[54:55], v114 offset:18944
  s_waitcnt lgkmcnt(2)
  v_mfma_f32_32x32x16_bf16 v[16:31], v[48:51], v[160:163], v[16:31]
  ds_read_b64_tr_b16 v[56:57], v114 offset:20480
  ds_read_b64_tr_b16 v[58:59], v114 offset:20992
  s_waitcnt lgkmcnt(2)
  v_mfma_f32_32x32x16_bf16 v[16:31], v[52:55], v[164:167], v[16:31]
  ds_read_b64_tr_b16 v[60:61], v114 offset:22528
  ds_read_b64_tr_b16 v[62:63], v114 offset:23040
  s_waitcnt lgkmcnt(2)
  v_mfma_f32_32x32x16_bf16 v[16:31], v[56:59], v[168:171], v[16:31]
  ds_read_b64_tr_b16 v[48:49], v114 offset:24576
  ds_read_b64_tr_b16 v[50:51], v114 offset:25088
  s_waitcnt lgkmcnt(2)
  v_mfma_f32_32x32x16_bf16 v[16:31], v[60:63], v[172:175], v[16:31]
  ds_read_b64_tr_b16 v[52:53], v114 offset:26624
  ds_read_b64_tr_b16 v[54:55], v114 offset:27136
  s_add_u32 m0, s55, 0
  s_add_u32 s40, s84, 32768
  buffer_load_dwordx4 v4, s[12:15], s84 offen lds
  s_add_u32 m0, s55, 8192
  s_nop 0
  buffer_load_dwordx4 v4, s[12:15], s40 offen lds
  s_waitcnt vmcnt(2)
  s_mov_b32 s24, 0
P1_fl10:
  v_cmp_ne_u32 vcc, s54, v125
  s_nop 4
  s_cmp_eq_u64 vcc, 0
  s_cbranch_scc1 P1_fo9
  s_add_u32 s24, s24, 1
  s_cmp_ge_u32 s24, 0x8000
  s_cbranch_scc1 P1_fo9
  s_mov_b32 s41, 20480
  buffer_load_dword v125, v124, s[16:19], s41 offen sc1
  s_waitcnt vmcnt(0)
  s_branch P1_fl10
P1_fo9:
  s_mov_b32 s3, s24
  s_cmp_eq_u32 s34, 0
  s_cbranch_scc0 P1_rz11
  buffer_load_dwordx4 v[72:75], v117, s[16:19], s59 offen sc1
P1_rz11:
  buffer_load_dwordx4 v[118:121], v0, s[16:19], s58 offen sc1
  s_waitcnt lgkmcnt(2)
  v_mfma_f32_32x32x16_bf16 v[16:31], v[48:51], v[176:179], v[16:31]
  ds_read_b64_tr_b16 v[56:57], v114 offset:28672
  ds_read_b64_tr_b16 v[58:59], v114 offset:29184
  s_waitcnt lgkmcnt(2)
  v_mfma_f32_32x32x16_bf16 v[16:31], v[52:55], v[180:183], v[16:31]
  ds_read_b64_tr_b16 v[60:61], v114 offset:30720
  ds_read_b64_tr_b16 v[62:63], v114 offset:31232
  s_waitcnt lgkmcnt(2)
  v_mfma_f32_32x32x16_bf16 v[16:31], v[56:59], v[184:187], v[16:31]
  ds_read_b64_tr_b16 v[48:49], v114 offset:32768
  ds_read_b64_tr_b16 v[50:51], v114 offset:33280
  s_waitcnt lgkmcnt(2)
  v_mfma_f32_32x32x16_bf16 v[16:31], v[60:63], v[188:191], v[16:31]
  ds_read_b64_tr_b16 v[52:53], v114 offset:34816
  ds_read_b64_tr_b16 v[54:55], v114 offset:35328
  s_waitcnt lgkmcnt(2)
  v_mfma_f32_32x32x16_bf16 v[16:31], v[48:51], v[192:195], v[16:31]
  ds_read_b64_tr_b16 v[56:57], v114 offset:36864
  ds_read_b64_tr_b16 v[58:59], v114 offset:37376
  s_waitcnt lgkmcnt(2)
  v_mfma_f32_32x32x16_bf16 v[16:31], v[52:55], v[196:199], v[16:31]
  ds_read_b64_tr_b16 v[60:61], v114 offset:38912
  ds_read_b64_tr_b16 v[62:63], v114 offset:39424
  s_waitcnt lgkmcnt(2)
  v_mfma_f32_32x32x16_bf16 v[16:31], v[56:59], v[200:203], v[16:31]
  ds_read_b64_tr_b16 v[48:49], v114 offset:40960
  ds_read_b64_tr_b16 v[50:51], v114 offset:41472
  s_waitcnt lgkmcnt(2)
  v_mfma_f32_32x32x16_bf16 v[16:31], v[60:63], v[204:207], v[16:31]
  ds_read_b64_tr_b16 v[52:53], v114 offset:43008
  ds_read_b64_tr_b16 v[54:55], v114 offset:43520
  s_waitcnt lgkmcnt(2)
  v_mfma_f32_32x32x16_bf16 v[16:31], v[48:51], v[208:211], v[16:31]
  ds_read_b64_tr_b16 v[56:57], v114 offset:45056
  ds_read_b64_tr_b16 v[58:59], v114 offset:45568
  s_waitcnt lgkmcnt(2)
  v_mfma_f32_32x32x16_bf16 v[16:31], v[52:55], v[212:215], v[16:31]
  ds_read_b64_tr_b16 v[60:61], v114 offset:47104
  ds_read_b64_tr_b16 v[62:63], v114 offset:47616
  s_add_u32 m0, s55, 16384
  s_add_u32 s40, s85, 32768
  buffer_load_dwordx4 v4, s[12:15], s85 offen lds
  s_add_u32 m0, s55, 24576
  s_nop 0
  buffer_load_dwordx4 v4, s[12:15], s40 offen lds
  s_waitcnt lgkmcnt(2)
  v_mfma_f32_32x32x16_bf16 v[16:31], v[56:59], v[216:219], v[16:31]
  ds_read_b64_tr_b16 v[48:49], v114 offset:49152
  ds_read_b64_tr_b16 v[50:51], v114 offset:49664
  s_waitcnt lgkmcnt(2)
  v_mfma_f32_32x32x16_bf16 v[16:31], v[60:63], v[220:223], v[16:31]
  ds_read_b64_tr_b16 v[52:53], v114 offset:51200
  ds_read_b64_tr_b16 v[54:55], v114 offset:51712
  s_waitcnt lgkmcnt(2)
  v_mfma_f32_32x32x16_bf16 v[16:31], v[48:51], v[224:227], v[16:31]
  ds_read_b64_tr_b16 v[56:57], v114 offset:53248
  ds_read_b64_tr_b16 v[58:59], v114 offset:53760
  s_waitcnt lgkmcnt(2)
  v_mfma_f32_32x32x16_bf16 v[16:31], v[52:55], v[228:231], v[16:31]
  ds_read_b64_tr_b16 v[60:61], v114 offset:55296
  ds_read_b64_tr_b16 v[62:63], v114 offset:55808
  s_waitcnt lgkmcnt(2)
  v_mfma_f32_32x32x16_bf16 v[16:31], v[56:59], v[232:235], v[16:31]
  ds_read_b64_tr_b16 v[48:49], v114 offset:57344
  ds_read_b64_tr_b16 v[50:51], v114 offset:57856
  s_waitcnt lgkmcnt(2)
  v_mfma_f32_32x32x16_bf16 v[16:31], v[60:63], v[236:239], v[16:31]
  ds_read_b64_tr_b16 v[52:53], v114 offset:59392
  ds_read_b64_tr_b16 v[54:55], v114 offset:59904
  s_waitcnt vmcnt(2)
  s_mov_b32 s24, 0
P1_rl13:
  s_mov_b32 s44, 0x0c0c0400
  v_perm_b32 v124, v119, v118, s44
  s_mov_b32 s44, 0x04000c0c
  v_perm_b32 v125, v121, v120, s44
  v_or_b32 v124, v124, v125
  v_cmp_ne_u32 vcc, s25, v124
  s_nop 4
  s_cmp_eq_u64 vcc, 0
  s_cbranch_scc1 P1_ro12
  s_add_u32 s24, s24, 1
  s_cmp_ge_u32 s24, 0x8000
  s_cbranch_scc1 P1_ro12
  s_sleep 2
  buffer_load_dwordx4 v[118:121], v0, s[16:19], s58 offen sc1
  s_waitcnt vmcnt(0)
  s_branch P1_rl13
P1_ro12:
  s_mov_b32 s39, s24
  v_add_f32_dpp v118, v118, v118 row_ror:4 row_mask:0xf bank_mask:0xf
  v_add_f32_dpp v119, v119, v119 row_ror:4 row_mask:0xf bank_mask:0xf
  v_add_f32_dpp v120, v120, v120 row_ror:4 row_mask:0xf bank_mask:0xf
  v_add_f32_dpp v121, v121, v121 row_ror:4 row_mask:0xf bank_mask:0xf
  v_add_f32_dpp v118, v118, v118 row_ror:8 row_mask:0xf bank_mask:0xf
  v_add_f32_dpp v119, v119, v119 row_ror:8 row_mask:0xf bank_mask:0xf
  v_add_f32_dpp v120, v120, v120 row_ror:8 row_mask:0xf bank_mask:0xf
  v_add_f32_dpp v121, v121, v121 row_ror:8 row_mask:0xf bank_mask:0xf
  v_mov_b32 v64, v118
  v_mov_b32 v65, v119
  v_mov_b32 v66, v120
  v_mov_b32 v67, v121
  v_permlane16_swap_b32 v118, v64
  v_permlane16_swap_b32 v119, v65
  v_permlane16_swap_b32 v120, v66
  v_permlane16_swap_b32 v121, v67
  v_add_f32 v118, v118, v64
  v_add_f32 v119, v119, v65
  v_add_f32 v120, v120, v66
  v_add_f32 v121, v121, v67
  v_mov_b32 v64, v118
  v_mov_b32 v65, v119
  v_mov_b32 v66, v120
  v_mov_b32 v67, v121
  v_permlane32_swap_b32 v118, v64
  v_permlane32_swap_b32 v119, v65
  v_permlane32_swap_b32 v120, v66
  v_permlane32_swap_b32 v121, v67
  v_add_f32 v118, v118, v64
  v_add_f32 v119, v119, v65
  v_add_f32 v120, v120, v66
  v_add_f32 v121, v121, v67
  v_cvt_pk_bf16_f32 v64, v118, v119
  v_cvt_pk_bf16_f32 v65, v120, v121
  s_cmp_ge_u32 s34, 4
  s_cbranch_scc1 P1_rs14
  s_mov_b64 exec, 15
  buffer_store_dwordx2 v[64:65], v2, s[16:19], s67 offen sc1
  s_mov_b64 exec, -1
P1_rs14:
  s_cmp_eq_u32 s34, 0
  s_cbranch_scc0 P1_rz15
  s_mov_b32 s24, 0
P1_rz17:
  s_mov_b32 s44, 0x0c0c0400
  v_perm_b32 v124, v73, v72, s44
  s_mov_b32 s44, 0x04000c0c
  v_perm_b32 v125, v75, v74, s44
  v_or_b32 v124, v124, v125
  v_cmp_ne_u32 vcc, s25, v124
  s_nop 4
  s_cmp_eq_u64 vcc, 0
  s_cbranch_scc1 P1_rz16
  s_add_u32 s24, s24, 1
  s_cmp_ge_u32 s24, 0x8000
  s_cbranch_scc1 P1_rz16
  s_sleep 2
  buffer_load_dwordx4 v[72:75], v117, s[16:19], s59 offen sc1
  s_waitcnt vmcnt(0)
  s_branch P1_rz17
P1_rz16:
  v_add_f32_dpp v72, v72, v72 row_ror:4 row_mask:0xf bank_mask:0xf
  v_add_f32_dpp v73, v73, v73 row_ror:4 row_mask:0xf bank_mask:0xf
  v_add_f32_dpp v74, v74, v74 row_ror:4 row_mask:0xf bank_mask:0xf
  v_add_f32_dpp v75, v75, v75 row_ror:4 row_mask:0xf bank_mask:0xf
  v_add_f32_dpp v72, v72, v72 row_ror:8 row_mask:0xf bank_mask:0xf
  v_add_f32_dpp v73, v73, v73 row_ror:8 row_mask:0xf bank_mask:0xf
  v_add_f32_dpp v74, v74, v74 row_ror:8 row_mask:0xf bank_mask:0xf
  v_add_f32_dpp v75, v75, v75 row_ror:8 row_mask:0xf bank_mask:0xf
  v_mov_b32 v68, v72
  v_mov_b32 v69, v73
  v_mov_b32 v70, v74
  v_mov_b32 v71, v75
  v_permlane16_swap_b32 v72, v68
  v_permlane16_swap_b32 v73, v69
  v_permlane16_swap_b32 v74, v70
  v_permlane16_swap_b32 v75, v71
  v_add_f32 v72, v72, v68
  v_add_f32 v73, v73, v69
  v_add_f32 v74, v74, v70
  v_add_f32 v75, v75, v71
  v_mov_b32 v68, v72
  v_mov_b32 v69, v73
  v_mov_b32 v70, v74
  v_mov_b32 v71, v75
  v_permlane32_swap_b32 v72, v68
  v_permlane32_swap_b32 v73, v69
  v_permlane32_swap_b32 v74, v70
  v_permlane32_swap_b32 v75, v71
  v_add_f32 v72, v72, v68
  v_add_f32 v73, v73, v69
  v_add_f32 v74, v74, v70
  v_add_f32 v75, v75, v71
  v_cvt_pk_bf16_f32 v68, v72, v73
  v_cvt_pk_bf16_f32 v69, v74, v75
  v_mov_b32 v124, 0
  s_mov_b64 exec, 1
  buffer_store_dwordx2 v[68:69], v124, s[16:19], s68 offen sc1
  s_mov_b64 exec, -1
P1_rz15:
  s_waitcnt lgkmcnt(2)
  v_mfma_f32_32x32x16_bf16 v[16:31], v[48:51], v[240:243], v[16:31]
  ds_read_b64_tr_b16 v[56:57], v114 offset:61440
  ds_read_b64_tr_b16 v[58:59], v114 offset:61952
  s_waitcnt lgkmcnt(2)
  v_mfma_f32_32x32x16_bf16 v[16:31], v[52:55], v[244:247], v[16:31]
  ds_read_b64_tr_b16 v[60:61], v114 offset:63488
  ds_read_b64_tr_b16 v[62:63], v114 offset:64000
  s_waitcnt lgkmcnt(2)
  v_mfma_f32_32x32x16_bf16 v[16:31], v[56:59], v[248:251], v[16:31]
  s_waitcnt lgkmcnt(0)
  v_mfma_f32_32x32x16_bf16 v[16:31], v[60:63], v[252:255], v[16:31]
  s_add_u32 m0, s55, 32768
  s_add_u32 s40, s86, 32768
  buffer_load_dwordx4 v4, s[12:15], s86 offen lds
  s_add_u32 m0, s55, 40960
  s_nop 0
  buffer_load_dwordx4 v4, s[12:15], s40 offen lds
  s_nop 5
  v_mul_f32 v88, v126, v16
  v_mul_f32 v89, v126, v17
  v_mul_f32 v90, v126, v18
  v_mul_f32 v91, v126, v19
  v_mul_f32 v92, v126, v20
  v_mul_f32 v93, v126, v21
  v_mul_f32 v94, v126, v22
  v_mul_f32 v95, v126, v23
  v_mul_f32 v96, v126, v24
  v_mul_f32 v97, v126, v25
  v_mul_f32 v98, v126, v26
  v_mul_f32 v99, v126, v27
  v_mul_f32 v100, v126, v28
  v_mul_f32 v101, v126, v29
  v_mul_f32 v102, v126, v30
  v_mul_f32 v103, v126, v31
  v_min_f32 v88, 0, v88
  v_min_f32 v89, 0, v89
  v_min_f32 v90, 0, v90
  v_min_f32 v91, 0, v91
  v_min_f32 v92, 0, v92
  v_min_f32 v93, 0, v93
  v_min_f32 v94, 0, v94
  v_min_f32 v95, 0, v95
  v_min_f32 v96, 0, v96
  v_min_f32 v97, 0, v97
  v_min_f32 v98, 0, v98
  v_min_f32 v99, 0, v99
  v_min_f32 v100, 0, v100
  v_min_f32 v101, 0, v101
  v_min_f32 v102, 0, v102
  v_min_f32 v103, 0, v103
  v_exp_f32 v88, v88
  v_max_f32 v16, 0, v16
  v_exp_f32 v89, v89
  v_max_f32 v17, 0, v17
  v_exp_f32 v90, v90
  v_max_f32 v18, 0, v18
  v_exp_f32 v91, v91
  v_max_f32 v19, 0, v19
  v_exp_f32 v92, v92
  v_max_f32 v20, 0, v20
  v_exp_f32 v93, v93
  v_max_f32 v21, 0, v21
  v_exp_f32 v94, v94
  v_max_f32 v22, 0, v22
  v_exp_f32 v95, v95
  v_max_f32 v23, 0, v23
  v_exp_f32 v96, v96
  v_max_f32 v24, 0, v24
  v_exp_f32 v97, v97
  v_max_f32 v25, 0, v25
  v_exp_f32 v98, v98
  v_max_f32 v26, 0, v26
  v_exp_f32 v99, v99
  v_max_f32 v27, 0, v27
  v_exp_f32 v100, v100
  v_max_f32 v28, 0, v28
  v_exp_f32 v101, v101
  v_max_f32 v29, 0, v29
  v_exp_f32 v102, v102
  v_max_f32 v30, 0, v30
  v_exp_f32 v103, v103
  v_max_f32 v31, 0, v31
  v_add_f32 v16, v127, v16
  v_add_f32 v17, v127, v17
  v_add_f32 v18, v127, v18
  v_add_f32 v19, v127, v19
  v_add_f32 v20, v127, v20
  v_add_f32 v21, v127, v21
  v_add_f32 v22, v127, v22
  v_add_f32 v23, v127, v23
  v_add_f32 v24, v127, v24
  v_add_f32 v25, v127, v25
  v_add_f32 v26, v127, v26
  v_add_f32 v27, v127, v27
  v_add_f32 v28, v127, v28
  v_add_f32 v29, v127, v29
  v_add_f32 v30, v127, v30
  v_add_f32 v31, v127, v31
  v_add_f32 v88, v88, v16
  v_add_f32 v89, v89, v17
  v_add_f32 v90, v90, v18
  v_add_f32 v91, v91, v19
  v_add_f32 v92, v92, v20
  v_add_f32 v93, v93, v21
  v_add_f32 v94, v94, v22
  v_add_f32 v95, v95, v23
  v_add_f32 v96, v96, v24
  v_add_f32 v97, v97, v25
  v_add_f32 v98, v98, v26
  v_add_f32 v99, v99, v27
  v_add_f32 v100, v100, v28
  v_add_f32 v101, v101, v29
  v_add_f32 v102, v102, v30
  v_add_f32 v103, v103, v31
  v_cvt_pk_bf16_f32 v16, v88, v89
  v_cvt_pk_bf16_f32 v17, v90, v91
  v_cvt_pk_bf16_f32 v18, v92, v93
  v_cvt_pk_bf16_f32 v19, v94, v95
  v_cvt_pk_bf16_f32 v20, v96, v97
  v_cvt_pk_bf16_f32 v21, v98, v99
  v_cvt_pk_bf16_f32 v22, v100, v101
  v_cvt_pk_bf16_f32 v23, v102, v103
  s_waitcnt vmcnt(0)
  s_barrier
  buffer_load_dwordx4 v[48:51], v13, s[16:19], s65 offen sc1
  buffer_load_dwordx4 v[112:115], v3, s[16:19], s66 offen sc1
  v_lshrrev_b32 v14, 5, v1
  v_bfe_u32 v15, v1, 2, 2
  v_lshl_add_u32 v14, v14, 2, v15
  v_lshlrev_b32 v5, 8, v14
  v_lshlrev_b32 v15, 2, v15
  v_bfe_u32 v14, v1, 4, 1
  v_lshlrev_b32 v14, 1, v14
  v_bfe_u32 v6, v1, 1, 1
  v_add_u32 v14, v14, v6
  s_and_b32 s41, s34, 3
  s_lshl_b32 s41, s41, 2
  v_add_u32 v14, s41, v14
  v_xor_b32 v14, v14, v15
  v_lshl_add_u32 v5, v14, 4, v5
  v_and_b32 v15, 1, v1
  v_lshl_add_u32 v5, v15, 3, v5
  v_add_u32 v6, 0x10000, v5
  v_add_u32 v7, 0x20000, v5
  ds_read_b64_tr_b16 v[128:129], v5 offset:49152
  ds_read_b64_tr_b16 v[130:131], v5 offset:51200
  ds_read_b64_tr_b16 v[132:133], v5 offset:53248
  ds_read_b64_tr_b16 v[134:135], v5 offset:55296
  ds_read_b64_tr_b16 v[136:137], v5 offset:57344
  ds_read_b64_tr_b16 v[138:139], v5 offset:59392
  ds_read_b64_tr_b16 v[140:141], v5 offset:61440
  ds_read_b64_tr_b16 v[142:143], v5 offset:63488
  ds_read_b64_tr_b16 v[144:145], v6 offset:0
  ds_read_b64_tr_b16 v[146:147], v6 offset:2048
  ds_read_b64_tr_b16 v[148:149], v6 offset:4096
  ds_read_b64_tr_b16 v[150:151], v6 offset:6144
  ds_read_b64_tr_b16 v[152:153], v6 offset:8192
  ds_read_b64_tr_b16 v[154:155], v6 offset:10240
  ds_read_b64_tr_b16 v[156:157], v6 offset:12288
  ds_read_b64_tr_b16 v[158:159], v6 offset:14336
  ds_read_b64_tr_b16 v[160:161], v6 offset:16384
  ds_read_b64_tr_b16 v[162:163], v6 offset:18432
  ds_read_b64_tr_b16 v[164:165], v6 offset:20480
  ds_read_b64_tr_b16 v[166:167], v6 offset:22528
  ds_read_b64_tr_b16 v[168:169], v6 offset:24576
  ds_read_b64_tr_b16 v[170:171], v6 offset:26624
  ds_read_b64_tr_b16 v[172:173], v6 offset:28672
  ds_read_b64_tr_b16 v[174:175], v6 offset:30720
  ds_read_b64_tr_b16 v[176:177], v5 offset:0
  ds_read_b64_tr_b16 v[178:179], v5 offset:2048
  ds_read_b64_tr_b16 v[180:181], v5 offset:4096
  ds_read_b64_tr_b16 v[182:183], v5 offset:6144
  ds_read_b64_tr_b16 v[184:185], v5 offset:8192
  ds_read_b64_tr_b16 v[186:187], v5 offset:10240
  ds_read_b64_tr_b16 v[188:189], v5 offset:12288
  ds_read_b64_tr_b16 v[190:191], v5 offset:14336
  ds_read_b64_tr_b16 v[192:193], v5 offset:16384
  ds_read_b64_tr_b16 v[194:195], v5 offset:18432
  ds_read_b64_tr_b16 v[196:197], v5 offset:20480
  ds_read_b64_tr_b16 v[198:199], v5 offset:22528
  ds_read_b64_tr_b16 v[200:201], v5 offset:24576
  ds_read_b64_tr_b16 v[202:203], v5 offset:26624
  ds_read_b64_tr_b16 v[204:205], v5 offset:28672
  ds_read_b64_tr_b16 v[206:207], v5 offset:30720
  ds_read_b64_tr_b16 v[208:209], v5 offset:32768
  ds_read_b64_tr_b16 v[210:211], v5 offset:34816
  ds_read_b64_tr_b16 v[212:213], v5 offset:36864
  ds_read_b64_tr_b16 v[214:215], v5 offset:38912
  ds_read_b64_tr_b16 v[216:217], v5 offset:40960
  ds_read_b64_tr_b16 v[218:219], v5 offset:43008
  ds_read_b64_tr_b16 v[220:221], v5 offset:45056
  ds_read_b64_tr_b16 v[222:223], v5 offset:47104
  s_waitcnt vmcnt(0)
  s_mov_b32 s24, 0
P1_al19:
  v_max3_u32 v66, v48, v49, v50
  v_max3_u32 v66, v66, v51, v112
  v_max3_u32 v66, v66, v113, v114
  v_max_u32 v66, v66, v115
  v_cmp_eq_u32 vcc, -1, v66
  s_nop 4
  s_cmp_eq_u64 vcc, 0
  s_cbranch_scc1 P1_ao18
  s_add_u32 s24, s24, 1
  s_cmp_ge_u32 s24, 0x8000
  s_cbranch_scc1 P1_ao18
  s_sleep 4
  buffer_load_dwordx4 v[48:51], v13, s[16:19], s65 offen sc1
  buffer_load_dwordx4 v[112:115], v3, s[16:19], s66 offen sc1
  s_waitcnt vmcnt(0)
  s_branch P1_al19
P1_ao18:
  s_mov_b32 s26, s24
  v_mov_b32 v56, v48
  v_mov_b32 v57, v49
  v_mov_b32 v58, v50
  v_mov_b32 v59, v51
  s_mov_b64 exec, s[62:63]
  v_mov_b32 v56, v112
  v_mov_b32 v57, v113
  v_mov_b32 v58, v114
  v_mov_b32 v59, v115
  s_mov_b64 exec, s[60:61]
  v_mov_b32 v48, v112
  v_mov_b32 v49, v113
  v_mov_b32 v50, v114
  v_mov_b32 v51, v115
  s_mov_b64 exec, -1
  s_nop 0
  v_mfma_f32_32x32x16_bf16 v[32:47], v[48:51], v[16:19], 0
  v_mfma_f32_32x32x16_bf16 v[72:87], v[56:59], v[20:23], 0
  s_nop 10
  v_add_f32 v64, v127, v40
  v_add_f32 v65, v127, v72
  v_rcp_f32 v64, v64
  v_rcp_f32 v65, v65
  v_mul_f32 v32, v32, v64
  v_mul_f32 v80, v80, v65
  v_mul_f32 v33, v33, v64
  v_mul_f32 v81, v81, v65
  v_mul_f32 v34, v34, v64
  v_mul_f32 v82, v82, v65
  v_mul_f32 v35, v35, v64
  v_mul_f32 v83, v83, v65
  v_mul_f32 v36, v36, v64
  v_mul_f32 v84, v84, v65
  v_mul_f32 v37, v37, v64
  v_mul_f32 v85, v85, v65
  v_mul_f32 v38, v38, v64
  v_mul_f32 v86, v86, v65
  v_mul_f32 v39, v39, v64
  v_mul_f32 v87, v87, v65
  v_cvt_pk_bf16_f32 v88, v32, v33
  v_cvt_pk_bf16_f32 v89, v34, v35
  v_cvt_pk_bf16_f32 v90, v36, v37
  v_cvt_pk_bf16_f32 v91, v38, v39
  v_cvt_pk_bf16_f32 v92, v80, v81
  v_cvt_pk_bf16_f32 v93, v82, v83
  v_cvt_pk_bf16_f32 v94, v84, v85
  v_cvt_pk_bf16_f32 v95, v86, v87
  v_mov_b32 v64, s96
  s_mov_b32 s44, 0xfffefffe
  v_and_or_b32 v88, v88, s44, v64
  v_and_or_b32 v89, v89, s44, v64
  v_and_or_b32 v90, v90, s44, v64
  v_and_or_b32 v91, v91, s44, v64
  v_and_or_b32 v92, v92, s44, v64
  v_and_or_b32 v93, v93, s44, v64
  v_and_or_b32 v94, v94, s44, v64
  v_and_or_b32 v95, v95, s44, v64
  buffer_store_dwordx4 v[88:91], v13, s[16:19], s64 offen sc1
  buffer_store_dwordx4 v[92:95], v13, s[16:19], s64 offen offset:1024 sc1
  s_waitcnt lgkmcnt(0)
  s_barrier
  s_add_u32 m0, s55, 49152
  s_add_u32 s40, s87, 32768
  buffer_load_dwordx4 v4, s[12:15], s87 offen lds
  s_add_u32 m0, s55, 57344
  s_nop 0
  buffer_load_dwordx4 v4, s[12:15], s40 offen lds
  s_add_u32 m0, s55, 65536
  s_add_u32 s40, s88, 32768
  buffer_load_dwordx4 v4, s[12:15], s88 offen lds
  s_add_u32 m0, s55, 73728
  s_nop 0
  buffer_load_dwordx4 v4, s[12:15], s40 offen lds
  v_and_b32 v112, 31, v1
  s_lshl_b32 s42, s36, 5
  v_add_u32 v112, s42, v112
  v_and_b32 v113, 15, v112
  s_lshl_b32 s42, s35, 2
  v_xor_b32 v113, s42, v113
  v_lshlrev_b32 v112, 8, v112
  v_lshrrev_b32 v114, 5, v1
  v_lshl_add_u32 v112, v114, 3, v112
  v_xor_b32 v96, 0, v113
  v_lshl_add_u32 v96, v96, 4, v112
  v_xor_b32 v97, 1, v113
  v_lshl_add_u32 v97, v97, 4, v112
  v_xor_b32 v98, 2, v113
  v_lshl_add_u32 v98, v98, 4, v112
  v_xor_b32 v99, 3, v113
  v_lshl_add_u32 v99, v99, 4, v112
  v_lshrrev_b32 v112, 4, v1
  s_lshl_b32 s42, s34, 3
  v_add_u32 v112, s42, v112
  v_and_b32 v113, 15, v1
  v_add_u32 v114, 0, v112
  v_and_b32 v100, 15, v114
  v_xor_b32 v100, v100, v113
  v_lshlrev_b32 v100, 4, v100
  v_lshl_add_u32 v100, v114, 8, v100
  v_add_u32 v114, 4, v112
  v_and_b32 v101, 15, v114
  v_xor_b32 v101, v101, v113
  v_lshlrev_b32 v101, 4, v101
  v_lshl_add_u32 v101, v114, 8, v101
  v_lshlrev_b32 v102, 11, v112
  v_lshl_add_u32 v102, v113, 4, v102
  s_lshl_b32 s41, s36, 15
  s_add_u32 s41, s41, 98304
  v_add_u32 v103, s41, v13
  s_waitcnt vmcnt(4)
  s_mov_b32 s24, 0
  v_add_u32 v14, s55, v13
  v_add_u32 v14, 98304, v14
P1_ol21:
  s_add_u32 m0, s55, 98304
  s_nop 0
  buffer_load_dwordx4 v13, s[16:19], s73 offen sc1 lds
  s_add_u32 m0, s55, 106496
  s_nop 0
  buffer_load_dwordx4 v13, s[16:19], s74 offen sc1 lds
  s_add_u32 m0, s55, 114688
  s_nop 0
  buffer_load_dwordx4 v13, s[16:19], s75 offen sc1 lds
  s_add_u32 m0, s55, 122880
  s_nop 0
  buffer_load_dwordx4 v13, s[16:19], s76 offen sc1 lds
  s_add_u32 m0, s55, 131072
  s_nop 0
  buffer_load_dwordx4 v13, s[16:19], s77 offen sc1 lds
  s_add_u32 m0, s55, 139264
  s_nop 0
  buffer_load_dwordx4 v13, s[16:19], s78 offen sc1 lds
  s_add_u32 m0, s55, 147456
  s_nop 0
  buffer_load_dwordx4 v13, s[16:19], s79 offen sc1 lds
  s_add_u32 m0, s55, 155648
  s_nop 0
  buffer_load_dwordx4 v13, s[16:19], s80 offen sc1 lds
  s_waitcnt vmcnt(0)
  ds_read_b128 v[32:35], v14 offset:0
  ds_read_b128 v[36:39], v14 offset:8192
  ds_read_b128 v[40:43], v14 offset:16384
  ds_read_b128 v[44:47], v14 offset:24576
  ds_read_b128 v[72:75], v14 offset:32768
  ds_read_b128 v[76:79], v14 offset:40960
  ds_read_b128 v[80:83], v14 offset:49152
  ds_read_b128 v[84:87], v14 offset:57344
  s_waitcnt lgkmcnt(0)
  v_mov_b32 v64, s96
  v_xor_b32 v15, v32, v64
  v_xor_b32 v65, v33, v64
  v_bitop3_b32 v15, v34, v64, v15 bitop3:0xbe
  v_bitop3_b32 v65, v35, v64, v65 bitop3:0xbe
  v_bitop3_b32 v15, v36, v64, v15 bitop3:0xbe
  v_bitop3_b32 v65, v37, v64, v65 bitop3:0xbe
  v_bitop3_b32 v15, v38, v64, v15 bitop3:0xbe
  v_bitop3_b32 v65, v39, v64, v65 bitop3:0xbe
  v_bitop3_b32 v15, v40, v64, v15 bitop3:0xbe
  v_bitop3_b32 v65, v41, v64, v65 bitop3:0xbe
  v_bitop3_b32 v15, v42, v64, v15 bitop3:0xbe
  v_bitop3_b32 v65, v43, v64, v65 bitop3:0xbe
  v_bitop3_b32 v15, v44, v64, v15 bitop3:0xbe
  v_bitop3_b32 v65, v45, v64, v65 bitop3:0xbe
  v_bitop3_b32 v15, v46, v64, v15 bitop3:0xbe
  v_bitop3_b32 v65, v47, v64, v65 bitop3:0xbe
  v_bitop3_b32 v15, v72, v64, v15 bitop3:0xbe
  v_bitop3_b32 v65, v73, v64, v65 bitop3:0xbe
  v_bitop3_b32 v15, v74, v64, v15 bitop3:0xbe
  v_bitop3_b32 v65, v75, v64, v65 bitop3:0xbe
  v_bitop3_b32 v15, v76, v64, v15 bitop3:0xbe
  v_bitop3_b32 v65, v77, v64, v65 bitop3:0xbe
  v_bitop3_b32 v15, v78, v64, v15 bitop3:0xbe
  v_bitop3_b32 v65, v79, v64, v65 bitop3:0xbe
  v_bitop3_b32 v15, v80, v64, v15 bitop3:0xbe
  v_bitop3_b32 v65, v81, v64, v65 bitop3:0xbe
  v_bitop3_b32 v15, v82, v64, v15 bitop3:0xbe
  v_bitop3_b32 v65, v83, v64, v65 bitop3:0xbe
  v_bitop3_b32 v15, v84, v64, v15 bitop3:0xbe
  v_bitop3_b32 v65, v85, v64, v65 bitop3:0xbe
  v_bitop3_b32 v15, v86, v64, v15 bitop3:0xbe
  v_bitop3_b32 v65, v87, v64, v65 bitop3:0xbe
  v_or_b32 v15, v15, v65
  v_and_b32 v15, 0x00010001, v15
  v_cmp_ne_u32 vcc, 0, v15
  s_nop 4
  s_cmp_eq_u64 vcc, 0
  s_cbranch_scc1 P1_oo20
  s_sleep 2
  s_add_u32 s24, s24, 1
  s_cmp_lt_u32 s24, 0x8000
  s_cbranch_scc1 P1_ol21
P1_oo20:
  s_mov_b32 s27, s24
  s_barrier
  ds_read_b128 v[48:51], v103 offset:0
  ds_read_b128 v[52:55], v103 offset:1024
  ds_read_b128 v[56:59], v103 offset:2048
  ds_read_b128 v[60:63], v103 offset:3072
  ds_read_b128 v[64:67], v103 offset:4096
  ds_read_b128 v[68:71], v103 offset:5120
  ds_read_b128 v[72:75], v103 offset:6144
  ds_read_b128 v[76:79], v103 offset:7168
  s_waitcnt lgkmcnt(7)
  v_mfma_f32_32x32x16_bf16 v[16:31], v[128:131], v[48:51], 0
  ds_read_b64_tr_b16 v[224:225], v5 offset:49152
  ds_read_b64_tr_b16 v[226:227], v5 offset:51200
  ds_read_b64_tr_b16 v[228:229], v5 offset:53248
  s_waitcnt lgkmcnt(9)
  v_mfma_f32_32x32x16_bf16 v[16:31], v[132:135], v[52:55], v[16:31]
  ds_read_b64_tr_b16 v[230:231], v5 offset:55296
  ds_read_b64_tr_b16 v[232:233], v5 offset:57344
  ds_read_b64_tr_b16 v[234:235], v5 offset:59392
  s_waitcnt lgkmcnt(11)
  v_mfma_f32_32x32x16_bf16 v[16:31], v[136:139], v[56:59], v[16:31]
  ds_read_b64_tr_b16 v[236:237], v5 offset:61440
  ds_read_b64_tr_b16 v[238:239], v5 offset:63488
  ds_read_b64_tr_b16 v[240:241], v6 offset:0
  s_waitcnt lgkmcnt(13)
  v_mfma_f32_32x32x16_bf16 v[16:31], v[140:143], v[60:63], v[16:31]
  ds_read_b64_tr_b16 v[242:243], v6 offset:2048
  ds_read_b64_tr_b16 v[244:245], v6 offset:4096
  ds_read_b64_tr_b16 v[246:247], v6 offset:6144
  ds_read_b128 v[48:51], v103 offset:8192
  ds_read_b128 v[52:55], v103 offset:9216
  ds_read_b128 v[56:59], v103 offset:10240
  ds_read_b128 v[60:63], v103 offset:11264
  s_waitcnt lgkmcnt(15)
  v_mfma_f32_32x32x16_bf16 v[16:31], v[144:147], v[64:67], v[16:31]
  ds_read_b64_tr_b16 v[248:249], v6 offset:8192
  ds_read_b64_tr_b16 v[250:251], v6 offset:10240
  ds_read_b64_tr_b16 v[252:253], v6 offset:12288
  s_waitcnt lgkmcnt(15)
  v_mfma_f32_32x32x16_bf16 v[16:31], v[148:151], v[68:71], v[16:31]
  ds_read_b64_tr_b16 v[254:255], v6 offset:14336
  s_waitcnt lgkmcnt(15)
  v_mfma_f32_32x32x16_bf16 v[16:31], v[152:155], v[72:75], v[16:31]
  s_waitcnt lgkmcnt(15)
  v_mfma_f32_32x32x16_bf16 v[16:31], v[156:159], v[76:79], v[16:31]
  ds_read_b128 v[64:67], v103 offset:12288
  ds_read_b128 v[68:71], v103 offset:13312
  ds_read_b128 v[72:75], v103 offset:14336
  ds_read_b128 v[76:79], v103 offset:15360
  s_waitcnt lgkmcnt(11)
  v_mfma_f32_32x32x16_bf16 v[16:31], v[160:163], v[48:51], v[16:31]
  s_waitcnt lgkmcnt(10)
  v_mfma_f32_32x32x16_bf16 v[16:31], v[164:167], v[52:55], v[16:31]
  s_waitcnt lgkmcnt(9)
  v_mfma_f32_32x32x16_bf16 v[16:31], v[168:171], v[56:59], v[16:31]
  s_waitcnt lgkmcnt(8)
  v_mfma_f32_32x32x16_bf16 v[16:31], v[172:175], v[60:63], v[16:31]
  ds_read_b128 v[48:51], v103 offset:16384
  ds_read_b128 v[52:55], v103 offset:17408
  ds_read_b128 v[56:59], v103 offset:18432
  ds_read_b128 v[60:63], v103 offset:19456
  s_waitcnt lgkmcnt(7)
  v_mfma_f32_32x32x16_bf16 v[16:31], v[176:179], v[64:67], v[16:31]
  s_waitcnt lgkmcnt(6)
  v_mfma_f32_32x32x16_bf16 v[16:31], v[180:183], v[68:71], v[16:31]
  s_waitcnt lgkmcnt(5)
  v_mfma_f32_32x32x16_bf16 v[16:31], v[184:187], v[72:75], v[16:31]
  s_waitcnt lgkmcnt(4)
  v_mfma_f32_32x32x16_bf16 v[16:31], v[188:191], v[76:79], v[16:31]
  ds_read_b128 v[64:67], v103 offset:20480
  ds_read_b128 v[68:71], v103 offset:21504
  ds_read_b128 v[72:75], v103 offset:22528
  ds_read_b128 v[76:79], v103 offset:23552
  s_waitcnt lgkmcnt(7)
  v_mfma_f32_32x32x16_bf16 v[16:31], v[192:195], v[48:51], v[16:31]
  s_waitcnt lgkmcnt(6)
  v_mfma_f32_32x32x16_bf16 v[16:31], v[196:199], v[52:55], v[16:31]
  s_waitcnt lgkmcnt(5)
  v_mfma_f32_32x32x16_bf16 v[16:31], v[200:203], v[56:59], v[16:31]
  s_waitcnt lgkmcnt(4)
  v_mfma_f32_32x32x16_bf16 v[16:31], v[204:207], v[60:63], v[16:31]
  ds_read_b128 v[48:51], v103 offset:24576
  ds_read_b128 v[52:55], v103 offset:25600
  ds_read_b128 v[56:59], v103 offset:26624
  ds_read_b128 v[60:63], v103 offset:27648
  s_waitcnt lgkmcnt(7)
  v_mfma_f32_32x32x16_bf16 v[16:31], v[208:211], v[64:67], v[16:31]
  s_waitcnt lgkmcnt(6)
  v_mfma_f32_32x32x16_bf16 v[16:31], v[212:215], v[68:71], v[16:31]
  s_waitcnt lgkmcnt(5)
  v_mfma_f32_32x32x16_bf16 v[16:31], v[216:219], v[72:75], v[16:31]
  s_waitcnt lgkmcnt(4)
  v_mfma_f32_32x32x16_bf16 v[16:31], v[220:223], v[76:79], v[16:31]
  ds_read_b128 v[64:67], v103 offset:28672
  ds_read_b128 v[68:71], v103 offset:29696
  ds_read_b128 v[72:75], v103 offset:30720
  ds_read_b128 v[76:79], v103 offset:31744
  s_waitcnt lgkmcnt(7)
  v_mfma_f32_32x32x16_bf16 v[16:31], v[224:227], v[48:51], v[16:31]
  s_waitcnt lgkmcnt(6)
  v_mfma_f32_32x32x16_bf16 v[16:31], v[228:231], v[52:55], v[16:31]
  s_waitcnt lgkmcnt(5)
  v_mfma_f32_32x32x16_bf16 v[16:31], v[232:235], v[56:59], v[16:31]
  s_waitcnt lgkmcnt(4)
  v_mfma_f32_32x32x16_bf16 v[16:31], v[236:239], v[60:63], v[16:31]
  s_waitcnt lgkmcnt(3)
  v_mfma_f32_32x32x16_bf16 v[16:31], v[240:243], v[64:67], v[16:31]
  s_waitcnt lgkmcnt(2)
  v_mfma_f32_32x32x16_bf16 v[16:31], v[244:247], v[68:71], v[16:31]
  s_waitcnt lgkmcnt(1)
  v_mfma_f32_32x32x16_bf16 v[16:31], v[248:251], v[72:75], v[16:31]
  s_waitcnt lgkmcnt(0)
  v_mfma_f32_32x32x16_bf16 v[16:31], v[252:255], v[76:79], v[16:31]
  s_nop 11
  v_cvt_pk_bf16_f32 v88, v16, v17
  v_cvt_pk_bf16_f32 v89, v18, v19
  v_cvt_pk_bf16_f32 v90, v20, v21
  v_cvt_pk_bf16_f32 v91, v22, v23
  v_cvt_pk_bf16_f32 v92, v24, v25
  v_cvt_pk_bf16_f32 v93, v26, v27
  v_cvt_pk_bf16_f32 v94, v28, v29
  v_cvt_pk_bf16_f32 v95, v30, v31
  ds_write_b64 v96, v[88:89]
  ds_write_b64 v97, v[90:91]
  ds_write_b64 v98, v[92:93]
  ds_write_b64 v99, v[94:95]
  s_waitcnt lgkmcnt(0)
  s_barrier
  ds_read_b128 v[88:91], v100
  ds_read_b128 v[92:95], v101
  s_add_u32 s40, s72, 8192
  s_waitcnt lgkmcnt(1)
  buffer_store_dwordx4 v[88:91], v102, s[20:23], s72 offen nt
  s_waitcnt lgkmcnt(0)
  buffer_store_dwordx4 v[92:95], v102, s[20:23], s40 offen nt
  s_add_u32 s41, s32, s33
  s_add_u32 s41, s41, s34
  s_cmp_eq_u32 s41, 0
  s_cbranch_scc0 P1_nu22
  v_mov_b32 v14, 0
  v_mov_b32 v15, s54
  s_mov_b64 exec, 1
  buffer_store_dword v15, v14, s[16:19], 0 offen offset:128 sc1
  s_mov_b64 exec, -1
P1_nu22:
  s_endpgm
.section .rodata,"a"
.p2align 6
.amdhsa_kernel concat_heads__linear_kernel_hedgehog__linear_attn_block__prompt_kernel
  .amdhsa_next_free_vgpr 256
  .amdhsa_next_free_sgpr 102
  .amdhsa_accum_offset 256
  .amdhsa_group_segment_fixed_size 0
  .amdhsa_kernarg_size 80
  .amdhsa_user_sgpr_count 2
  .amdhsa_user_sgpr_kernarg_segment_ptr 1
  .amdhsa_system_sgpr_workgroup_id_x 1
.end_amdhsa_kernel
```
